```python
import torch

def _softmax(x, axis=-1):
    return torch.softmax(x, dim=axis)
def _gelu(x):
    return torch.nn.functional.gelu(x, approximate="tanh")
def _silu(x):
    return torch.nn.functional.silu(x)
def _sigmoid(x):
    return torch.sigmoid(x)
def _layernorm(x, axis=-1, eps=1e-5):
    m = x.mean(dim=axis, keepdim=True)
    v = x.var(dim=axis, keepdim=True, unbiased=False)
    return (x - m) / torch.sqrt(v + eps)
def _scatter_add(tgt, idx, src, axis=0):
    return tgt.clone().index_add_(axis, idx, src)
def _segment_sum(src, seg, n):
    out = torch.zeros((n,) + src.shape[1:], dtype=src.dtype)
    return out.index_add_(0, seg, src)
def _pad(x, pw):
    flat = tuple(v for pair in reversed(pw) for v in pair)
    return torch.nn.functional.pad(x, flat)

kernel_name = 'sequential_preLN__linear_kernel_hedgehog__dense_activation_silu__prompt'

def setup_inputs():

    _w = (lambda a: (lambda t: t.to(torch.bfloat16) if t.is_floating_point() else t)(torch.as_tensor(a)))
    def _A_setup():
        B, S, D, H = 1, 2048, 448, 16
        Dh = D // H
        return {
            "x": _w((lambda *s: torch.randn(*s, dtype=torch.bfloat16) * 0.05)(B, S, D)),
            "wqkv": _w((lambda *s: torch.randn(*s, dtype=torch.bfloat16) * 0.2)(D, 3 * D)),
            "w_phi": _w((lambda *s: torch.randn(*s, dtype=torch.bfloat16) * 0.2)(H, Dh, Dh) * (Dh ** -0.5)),
            "wo": _w((lambda *s: torch.randn(*s, dtype=torch.bfloat16) * 0.05)(D, D)),
        }
    _A_in = _A_setup()

    def _B_setup():
        B, S, D, F = 1, 2048, 448, 1792
        return {
            "x": _w((lambda *s: torch.randn(*s, dtype=torch.bfloat16) * 0.05)(B, S, D)),
            "w1": _w((lambda *s: torch.randn(*s, dtype=torch.bfloat16) * 3.2)(D, F) * (D ** -0.5)),
            "w2": _w((lambda *s: torch.randn(*s, dtype=torch.bfloat16) * 0.1)(F, D) * (F ** -0.5)),
        }
    _B_in = _B_setup()

    return {
        "A_x": _A_in["x"],
        "A_wqkv": _A_in["wqkv"],
        "A_w_phi": _A_in["w_phi"],
        "A_wo": _A_in["wo"],
        "B_x": _B_in["x"],
        "B_w1": _B_in["w1"],
        "B_w2": _B_in["w2"],
    }

def reference(A_x, A_wqkv, A_w_phi, A_wo, B_x, B_w1, B_w2):
    def _A_ref(x, wqkv, w_phi, wo):
        B, S, D = x.shape
        H = 16; Dh = D // H
        qkv = (lambda x, *d: x.permute(*d))((x @ wqkv).reshape(B, S, 3, H, Dh), 2, 0, 3, 1, 4)
        q, k, v = qkv[0], qkv[1], qkv[2]
        pq = torch.einsum("bhsd,hdf->bhsf", q, w_phi)
        pk = torch.einsum("bhsd,hdf->bhsf", k, w_phi)
        phi_q = torch.concatenate([_softmax(pq, axis=-1), _softmax(-pq, axis=-1)], axis=-1)
        phi_k = torch.concatenate([_softmax(pk, axis=-1), _softmax(-pk, axis=-1)], axis=-1)
        kv = torch.einsum("bhsf,bhsd->bhfd", phi_k, v)
        z  = torch.einsum("bhsf->bhf", phi_k)
        num = torch.einsum("bhqf,bhfd->bhqd", phi_q, kv)
        den = torch.einsum("bhqf,bhf->bhq", phi_q, z)[..., None] + 1e-6
        o = num / den
        return (lambda x, *d: x.permute(*d))(o, 0, 2, 1, 3).reshape(B, S, D) @ wo

    def _B_ref(x, w1, w2):
        h = torch.einsum("bsd,df->bsf", x, w1)
        h = _silu(h)
        out = torch.einsum("bsf,fd->bsd", h, w2)
        return out

    x = A_x
    h = x + _A_ref(_layernorm(x, axis=-1), A_wqkv, A_w_phi, A_wo)
    h2 = h + _B_ref(_layernorm(h, axis=-1), B_w1, B_w2)
    return h2
```

```asm
; @launch grid=(256,1,1) block=(256,1,1) lds=163840
.amdgcn_target "amdgcn-amd-amdhsa--gfx950"
.text
.globl sequential_preLN__linear_kernel_hedgehog__dense_activation_silu__prompt_kernel
.p2align 8
.type sequential_preLN__linear_kernel_hedgehog__dense_activation_silu__prompt_kernel,@function
sequential_preLN__linear_kernel_hedgehog__dense_activation_silu__prompt_kernel:
  s_cmp_ge_u32 s2, 256
  s_cbranch_scc1 L_end
  s_load_dwordx2 s[8:9], s[0:1], 0
  s_getpc_b64 s[76:77]
  v_and_b32 v1, 63, v0
  v_lshrrev_b32 v2, 6, v0
  s_and_b32 s70, s2, 7
  v_readfirstlane_b32 s3, v2
  s_lshr_b32 s71, s2, 3
  s_and_b32 s72, s71, 15
  v_lshlrev_b32 v3, 4, v1
  v_lshl_add_u32 v3, v2, 6, v3
  v_lshl_add_u32 v3, v2, 4, v3
  v_add_u32 v3, s72, v3
  v_lshlrev_b32 v3, 7, v3
  s_and_b32 s76, s76, 0xffffff00
  s_mov_b64 exec, 31
  global_load_dword v236, v3, s[76:77]
  s_mov_b64 exec, -1
  s_lshr_b32 s4, s70, 1
  s_lshl_b32 s4, s4, 2
  s_and_b32 s73, s71, 3
  s_add_u32 s4, s4, s73
  s_and_b32 s59, s70, 1
  s_lshl_b32 s5, s59, 3
  s_lshr_b32 s73, s71, 2
  s_add_u32 s5, s5, s73
  s_mul_i32 s59, s4, 2
  s_add_u32 s73, s73, s59
  s_mul_i32 s59, s73, 37
  s_lshr_b32 s59, s59, 8
  s_mul_i32 s59, s59, 7
  s_sub_u32 s73, s73, s59
  s_lshl_b32 s40, s73, 7
  s_mov_b32 s10, 1835008
  s_mov_b32 s11, 0x20000
  v_lshrrev_b32 v2, 3, v1
  v_mul_u32_u24 v244, 896, v2
  v_lshrrev_b32 v2, 4, v1
  v_and_b32 v8, 7, v1
  v_xor_b32 v2, v2, v8
  v_lshl_add_u32 v244, v2, 4, v244
  v_xor_b32 v245, 64, v244
  v_add_u32 v245, 6144, v245
  v_add_u32 v246, 12288, v244
  v_add_u32 v247, 12288, v245
  s_lshl_b32 s63, s4, 2
  s_add_u32 s63, s63, s3
  s_mul_i32 s63, s63, 28672
  s_lshr_b32 s75, s3, 1
  s_add_u32 s75, s75, s3
  s_mul_i32 s75, s75, 28672
  s_waitcnt lgkmcnt(0)
  s_add_u32 m0, s75, 0
  s_add_u32 s72, s63, s40
  buffer_load_dwordx4 v244, s[8:11], s72 offen offset:0 lds
  buffer_load_dwordx4 v245, s[8:11], s72 offen offset:1024 lds
  buffer_load_dwordx4 v246, s[8:11], s72 offen offset:2048 lds
  buffer_load_dwordx4 v247, s[8:11], s72 offen offset:3072 lds
  s_load_dwordx2 s[12:13], s[0:1], 8
  s_load_dwordx2 s[16:17], s[0:1], 16
  s_load_dwordx2 s[20:21], s[0:1], 24
  s_load_dwordx2 s[24:25], s[0:1], 40
  s_load_dwordx2 s[28:29], s[0:1], 48
  s_load_dwordx2 s[32:33], s[0:1], 56
  s_load_dwordx2 s[36:37], s[0:1], 72
  s_mov_b32 s14, 1204224
  s_mov_b32 s15, 0x20000
  v_and_b32 v8, 3, v1
  s_add_u32 s41, s40, 128
  s_cmp_ge_u32 s41, 896
  s_cselect_b32 s73, 896, 0
  s_sub_u32 s41, s41, s73
  s_add_u32 m0, s75, 4096
  s_add_u32 s72, s63, s41
  buffer_load_dwordx4 v244, s[8:11], s72 offen offset:0 lds
  buffer_load_dwordx4 v245, s[8:11], s72 offen offset:1024 lds
  buffer_load_dwordx4 v246, s[8:11], s72 offen offset:2048 lds
  buffer_load_dwordx4 v247, s[8:11], s72 offen offset:3072 lds
  s_waitcnt lgkmcnt(0)
  s_mov_b32 s38, 16252928
  s_mov_b32 s39, 0x20000
  s_mov_b32 s18, 25088
  s_mov_b32 s19, 0x20000
  s_mov_b32 s22, 401408
  s_mov_b32 s23, 0x20000
  s_xor_b32 s54, s5, 1
  v_mov_b32 v11, 0
  v_lshlrev_b32 v6, 7, v1
  s_mov_b64 exec, 1
  buffer_load_dword v5, v6, s[36:39], 0 offen sc1
  s_lshl_b32 s56, s2, 2
  s_add_u32 s56, s56, s3
  s_lshl_b32 s56, s56, 9
  s_mov_b64 exec, 15
  buffer_load_dword v238, v6, s[20:23], s56 offen
  s_mov_b64 exec, -1
  s_add_u32 s42, s41, 128
  s_cmp_ge_u32 s42, 896
  s_cselect_b32 s73, 896, 0
  s_sub_u32 s42, s42, s73
  s_add_u32 s43, s42, 128
  s_cmp_ge_u32 s43, 896
  s_cselect_b32 s73, 896, 0
  s_sub_u32 s43, s43, s73
  s_add_u32 s44, s43, 128
  s_cmp_ge_u32 s44, 896
  s_cselect_b32 s73, 896, 0
  s_sub_u32 s44, s44, s73
  s_add_u32 s45, s44, 128
  s_cmp_ge_u32 s45, 896
  s_cselect_b32 s73, 896, 0
  s_sub_u32 s45, s45, s73
  s_add_u32 s46, s45, 128
  s_cmp_ge_u32 s46, 896
  s_cselect_b32 s73, 896, 0
  s_sub_u32 s46, s46, s73
  s_mov_b32 s68, 0x3f803f80
  s_mul_i32 s66, s5, 1568
  s_mul_i32 s81, s54, 1568
  s_lshl_b32 s6, s70, 1
  s_lshr_b32 s73, s71, 4
  s_add_u32 s6, s6, s73
  s_and_b32 s74, s71, 15
  s_min_u32 s7, s74, 13
  s_nop 0
  s_mov_b32 s26, 1605632
  s_mov_b32 s27, 0x20000
  s_mov_b32 s30, 1605632
  s_mov_b32 s31, 0x20000
  s_mov_b32 s34, 1835008
  s_mov_b32 s35, 0x20000
  s_mov_b32 s64, 0
  s_mov_b32 s65, -1
  s_mov_b32 s62, 0xbfffbfff
  s_mov_b32 s55, 0xffff0000
  s_mov_b32 s58, 0
  s_mov_b32 s80, 0
  s_cmp_ge_u32 s7, 7
  s_cselect_b32 s60, 1, 0
  s_mul_i32 s70, s60, 7
  s_sub_u32 s61, s7, s70
  s_and_b32 s70, s6, 12
  s_and_b32 s73, s6, 1
  s_lshl_b32 s73, s73, 1
  s_add_u32 s70, s70, s73
  s_add_u32 s67, s70, s60
  s_bfe_u32 s70, s6, 0x10001
  s_mul_i32 s70, s70, 7
  s_add_u32 s7, s70, s61
  s_nop 0
  s_mul_i32 s47, s40, 1344
  s_mul_i32 s48, s41, 1344
  s_mul_i32 s49, s42, 1344
  s_mul_i32 s50, s43, 1344
  s_mul_i32 s51, s44, 1344
  s_mul_i32 s52, s45, 1344
  s_mul_i32 s53, s46, 1344
  s_mul_i32 s76, s5, 56
  s_mul_i32 s73, s3, 43008
  s_add_u32 s76, s76, s73
  s_mul_i32 s77, s54, 56
  s_add_u32 s77, s77, s73
  s_add_u32 s76, s76, 896
  s_lshl_b32 s82, s3, 10
  v_lshrrev_b32 v3, 5, v1
  v_bfe_u32 v11, v1, 3, 2
  v_lshl_add_u32 v11, v11, 2, v8
  v_bfe_u32 v12, v1, 2, 1
  v_mul_u32_u24 v12, 14, v12
  v_min_u32 v13, 13, v11
  v_add_u32 v13, v13, v12
  v_lshlrev_b32 v13, 1, v13
  v_mul_u32_u24 v14, 224, v3
  v_add_u32 v128, v13, v14
  v_lshl_add_u32 v129, v3, 20, v128
  v_and_b32 v9, 31, v1
  v_lshlrev_b32 v240, 7, v9
  v_bfe_u32 v10, v1, 1, 3
  v_xor_b32 v10, v10, v3
  v_lshl_add_u32 v240, v10, 4, v240
  v_add_u32 v240, s75, v240
  v_xor_b32 v241, 32, v240
  v_xor_b32 v242, 64, v240
  v_xor_b32 v243, 96, v240
  v_mov_b32 v250, 0
  v_mov_b32 v251, 0
  v_lshlrev_b32 v2, 4, v1
  v_lshlrev_b32 v4, 2, v1
  v_add_u32 v12, v12, v11
  v_cmp_gt_u32 vcc, 14, v11
  v_lshrrev_b32 v7, 2, v1
  v_mul_u32_u24 v7, 2688, v7
  v_cndmask_b32 v12, 28, v12, vcc
  v_and_b32 v13, 15, v12
  v_lshlrev_b32 v13, 4, v13
  v_lshrrev_b32 v12, 4, v12
  v_lshl_add_u32 v13, v12, 3, v13
  v_lshl_add_u32 v13, v3, 8, v13
  v_add_u32 v130, 143360, v13
  v_lshlrev_b32 v11, 4, v8
  v_min_u32 v11, 40, v11
  v_add_u32_e64 v7, v7, v11
  buffer_load_short_d16 v192, v128, s[16:19], s66 offen offset:0
  buffer_load_short_d16_hi v208, v128, s[16:19], s66 offen offset:56
  buffer_load_short_d16 v193, v128, s[16:19], s66 offen offset:112
  buffer_load_short_d16_hi v209, v128, s[16:19], s66 offen offset:168
  buffer_load_short_d16 v194, v128, s[16:19], s66 offen offset:448
  buffer_load_short_d16_hi v210, v128, s[16:19], s66 offen offset:504
  buffer_load_short_d16 v195, v128, s[16:19], s66 offen offset:560
  buffer_load_short_d16_hi v211, v128, s[16:19], s66 offen offset:616
  buffer_load_short_d16 v196, v128, s[16:19], s66 offen offset:896
  buffer_load_short_d16_hi v212, v128, s[16:19], s66 offen offset:952
  buffer_load_short_d16 v197, v128, s[16:19], s66 offen offset:1008
  buffer_load_short_d16_hi v213, v128, s[16:19], s66 offen offset:1064
  buffer_load_short_d16 v198, v129, s[16:19], s66 offen offset:1344
  buffer_load_short_d16_hi v214, v129, s[16:19], s66 offen offset:1400
  buffer_load_short_d16 v199, v129, s[16:19], s66 offen offset:1456
  buffer_load_short_d16_hi v215, v129, s[16:19], s66 offen offset:1512
  buffer_load_short_d16 v200, v128, s[16:19], s81 offen offset:0
  buffer_load_short_d16_hi v216, v128, s[16:19], s81 offen offset:56
  buffer_load_short_d16 v201, v128, s[16:19], s81 offen offset:112
  buffer_load_short_d16_hi v217, v128, s[16:19], s81 offen offset:168
  buffer_load_short_d16 v202, v128, s[16:19], s81 offen offset:448
  buffer_load_short_d16_hi v218, v128, s[16:19], s81 offen offset:504
  buffer_load_short_d16 v203, v128, s[16:19], s81 offen offset:560
  buffer_load_short_d16_hi v219, v128, s[16:19], s81 offen offset:616
  buffer_load_short_d16 v204, v128, s[16:19], s81 offen offset:896
  buffer_load_short_d16_hi v220, v128, s[16:19], s81 offen offset:952
  buffer_load_short_d16 v205, v128, s[16:19], s81 offen offset:1008
  buffer_load_short_d16_hi v221, v128, s[16:19], s81 offen offset:1064
  buffer_load_short_d16 v206, v129, s[16:19], s81 offen offset:1344
  buffer_load_short_d16_hi v222, v129, s[16:19], s81 offen offset:1400
  buffer_load_short_d16 v207, v129, s[16:19], s81 offen offset:1456
  buffer_load_short_d16_hi v223, v129, s[16:19], s81 offen offset:1512
  s_add_u32 m0, s75, 8192
  s_add_u32 s72, s63, s42
  buffer_load_dwordx4 v244, s[8:11], s72 offen offset:0 lds
  buffer_load_dwordx4 v245, s[8:11], s72 offen offset:1024 lds
  buffer_load_dwordx4 v246, s[8:11], s72 offen offset:2048 lds
  buffer_load_dwordx4 v247, s[8:11], s72 offen offset:3072 lds
  s_waitcnt vmcnt(42)
  ds_read_b128 v[16:19], v240 offset:0
  ds_read_b128 v[20:23], v241 offset:0
  ds_read_b128 v[24:27], v242 offset:0
  ds_read_b128 v[28:31], v243 offset:0
  s_add_u32 m0, s75, 12288
  s_add_u32 s72, s63, s43
  buffer_load_dwordx4 v244, s[8:11], s72 offen offset:0 lds
  buffer_load_dwordx4 v245, s[8:11], s72 offen offset:1024 lds
  buffer_load_dwordx4 v246, s[8:11], s72 offen offset:2048 lds
  buffer_load_dwordx4 v247, s[8:11], s72 offen offset:3072 lds
  s_waitcnt vmcnt(42)
  ds_read_b128 v[32:35], v240 offset:4096
  ds_read_b128 v[36:39], v241 offset:4096
  ds_read_b128 v[40:43], v242 offset:4096
  ds_read_b128 v[44:47], v243 offset:4096
  s_waitcnt lgkmcnt(7)
  v_dot2c_f32_bf16 v250, s68, v16
  v_dot2c_f32_bf16 v251, v16, v16
  v_dot2c_f32_bf16 v250, s68, v17
  v_dot2c_f32_bf16 v251, v17, v17
  v_dot2c_f32_bf16 v250, s68, v18
  v_dot2c_f32_bf16 v251, v18, v18
  v_dot2c_f32_bf16 v250, s68, v19
  v_dot2c_f32_bf16 v251, v19, v19
  s_waitcnt lgkmcnt(6)
  v_dot2c_f32_bf16 v250, s68, v20
  v_dot2c_f32_bf16 v251, v20, v20
  v_dot2c_f32_bf16 v250, s68, v21
  v_dot2c_f32_bf16 v251, v21, v21
  v_dot2c_f32_bf16 v250, s68, v22
  v_dot2c_f32_bf16 v251, v22, v22
  v_dot2c_f32_bf16 v250, s68, v23
  v_dot2c_f32_bf16 v251, v23, v23
  s_waitcnt lgkmcnt(5)
  v_dot2c_f32_bf16 v250, s68, v24
  v_dot2c_f32_bf16 v251, v24, v24
  v_dot2c_f32_bf16 v250, s68, v25
  v_dot2c_f32_bf16 v251, v25, v25
  v_dot2c_f32_bf16 v250, s68, v26
  v_dot2c_f32_bf16 v251, v26, v26
  v_dot2c_f32_bf16 v250, s68, v27
  v_dot2c_f32_bf16 v251, v27, v27
  s_waitcnt lgkmcnt(4)
  v_dot2c_f32_bf16 v250, s68, v28
  v_dot2c_f32_bf16 v251, v28, v28
  v_dot2c_f32_bf16 v250, s68, v29
  v_dot2c_f32_bf16 v251, v29, v29
  v_dot2c_f32_bf16 v250, s68, v30
  v_dot2c_f32_bf16 v251, v30, v30
  v_dot2c_f32_bf16 v250, s68, v31
  v_dot2c_f32_bf16 v251, v31, v31
  s_lshl_b32 s70, s5, 4
  s_add_u32 s70, s70, s4
  s_mul_i32 s70, s70, 4608
  s_add_u32 s70, s70, 262144
  s_add_u32 s83, s70, s82
  s_lshl_b32 s73, s3, 7
  s_add_u32 s70, s70, s73
  s_add_u32 s84, s70, 4096
  s_lshl_b32 s70, s4, 2
  s_add_u32 s70, s70, s3
  s_lshl_b32 s70, s70, 15
  s_lshl_b32 s71, s54, 11
  s_add_u32 s70, s70, s71
  s_add_u32 s85, s70, 2359296
  s_lshl_b32 s70, s6, 2
  s_lshl_b32 s71, s60, 1
  s_add_u32 s70, s70, s71
  s_and_b32 s71, s3, 1
  s_add_u32 s69, s70, s71
  s_mul_i32 s70, s70, 28672
  s_lshl_b32 s71, s61, 7
  s_add_u32 s70, s70, s71
  s_mul_i32 s73, s3, 14336
  s_add_u32 s86, s70, s73
  s_mul_i32 s70, s69, 28672
  s_add_u32 s70, s70, s71
  s_lshr_b32 s71, s3, 1
  s_lshl_b32 s71, s71, 6
  s_add_u32 s87, s70, s71
  s_mul_i32 s59, s54, 73728
  s_add_u32 m0, s75, 16384
  s_add_u32 s72, s63, s44
  buffer_load_dwordx4 v244, s[8:11], s72 offen offset:0 lds
  buffer_load_dwordx4 v245, s[8:11], s72 offen offset:1024 lds
  buffer_load_dwordx4 v246, s[8:11], s72 offen offset:2048 lds
  buffer_load_dwordx4 v247, s[8:11], s72 offen offset:3072 lds
  s_waitcnt vmcnt(8)
  ds_read_b128 v[48:51], v240 offset:8192
  ds_read_b128 v[52:55], v241 offset:8192
  ds_read_b128 v[56:59], v242 offset:8192
  ds_read_b128 v[60:63], v243 offset:8192
  s_waitcnt lgkmcnt(7)
  v_dot2c_f32_bf16 v250, s68, v32
  v_dot2c_f32_bf16 v251, v32, v32
  v_dot2c_f32_bf16 v250, s68, v33
  v_dot2c_f32_bf16 v251, v33, v33
  v_dot2c_f32_bf16 v250, s68, v34
  v_dot2c_f32_bf16 v251, v34, v34
  v_dot2c_f32_bf16 v250, s68, v35
  v_dot2c_f32_bf16 v251, v35, v35
  s_waitcnt lgkmcnt(6)
  v_dot2c_f32_bf16 v250, s68, v36
  v_dot2c_f32_bf16 v251, v36, v36
  v_dot2c_f32_bf16 v250, s68, v37
  v_dot2c_f32_bf16 v251, v37, v37
  v_dot2c_f32_bf16 v250, s68, v38
  v_dot2c_f32_bf16 v251, v38, v38
  v_dot2c_f32_bf16 v250, s68, v39
  v_dot2c_f32_bf16 v251, v39, v39
  s_waitcnt lgkmcnt(5)
  v_dot2c_f32_bf16 v250, s68, v40
  v_dot2c_f32_bf16 v251, v40, v40
  v_dot2c_f32_bf16 v250, s68, v41
  v_dot2c_f32_bf16 v251, v41, v41
  v_dot2c_f32_bf16 v250, s68, v42
  v_dot2c_f32_bf16 v251, v42, v42
  v_dot2c_f32_bf16 v250, s68, v43
  v_dot2c_f32_bf16 v251, v43, v43
  s_waitcnt lgkmcnt(4)
  v_dot2c_f32_bf16 v250, s68, v44
  v_dot2c_f32_bf16 v251, v44, v44
  v_dot2c_f32_bf16 v250, s68, v45
  v_dot2c_f32_bf16 v251, v45, v45
  v_dot2c_f32_bf16 v250, s68, v46
  v_dot2c_f32_bf16 v251, v46, v46
  v_dot2c_f32_bf16 v250, s68, v47
  v_dot2c_f32_bf16 v251, v47, v47
  s_add_u32 s59, s59, 262144
  s_lshl_b32 s70, s3, 5
  v_add_u32 v10, s70, v9
  v_mul_u32_u24 v10, 208, v10
  v_mul_u32_u24 v11, 96, v3
  v_add_u32 v131, v10, v11
  v_lshrrev_b32 v10, 4, v1
  v_bfe_u32 v15, v1, 2, 2
  v_lshl_add_u32 v10, v10, 3, v15
  v_mul_u32_u24 v10, 208, v10
  v_and_b32 v11, 1, v1
  v_mul_u32_u24 v11, 96, v11
  v_add_u32 v10, v10, v11
  v_bfe_u32 v11, v1, 1, 1
  v_lshl_add_u32 v10, v11, 3, v10
  v_add_u32 v133, 57344, v10
  s_lshl_b32 s70, s3, 4
  v_add_u32 v132, s70, v133
  v_add_u32 v134, s82, v2
  s_lshl_b32 s73, s3, 7
  s_add_u32 s73, s73, 4096
  v_lshlrev_b32 v0, 1, v1
  v_add_u32 v135, s73, v0
  v_lshrrev_b32 v12, 3, v1
  v_mul_u32_u24 v14, 896, v12
  v_and_b32 v13, 7, v1
  v_xor_b32 v12, v12, v13
  v_lshl_add_u32 v138, v12, 4, v14
  v_add_u32 v139, 6144, v138
  v_bfe_u32 v12, v1, 4, 1
  s_add_u32 m0, s75, 20480
  s_add_u32 s72, s63, s45
  buffer_load_dwordx4 v244, s[8:11], s72 offen offset:0 lds
  buffer_load_dwordx4 v245, s[8:11], s72 offen offset:1024 lds
  buffer_load_dwordx4 v246, s[8:11], s72 offen offset:2048 lds
  buffer_load_dwordx4 v247, s[8:11], s72 offen offset:3072 lds
  s_waitcnt vmcnt(8)
  ds_read_b128 v[64:67], v240 offset:12288
  ds_read_b128 v[68:71], v241 offset:12288
  ds_read_b128 v[72:75], v242 offset:12288
  ds_read_b128 v[76:79], v243 offset:12288
  s_waitcnt lgkmcnt(7)
  v_dot2c_f32_bf16 v250, s68, v48
  v_dot2c_f32_bf16 v251, v48, v48
  v_dot2c_f32_bf16 v250, s68, v49
  v_dot2c_f32_bf16 v251, v49, v49
  v_dot2c_f32_bf16 v250, s68, v50
  v_dot2c_f32_bf16 v251, v50, v50
  v_dot2c_f32_bf16 v250, s68, v51
  v_dot2c_f32_bf16 v251, v51, v51
  s_waitcnt lgkmcnt(6)
  v_dot2c_f32_bf16 v250, s68, v52
  v_dot2c_f32_bf16 v251, v52, v52
  v_dot2c_f32_bf16 v250, s68, v53
  v_dot2c_f32_bf16 v251, v53, v53
  v_dot2c_f32_bf16 v250, s68, v54
  v_dot2c_f32_bf16 v251, v54, v54
  v_dot2c_f32_bf16 v250, s68, v55
  v_dot2c_f32_bf16 v251, v55, v55
  s_waitcnt lgkmcnt(5)
  v_dot2c_f32_bf16 v250, s68, v56
  v_dot2c_f32_bf16 v251, v56, v56
  v_dot2c_f32_bf16 v250, s68, v57
  v_dot2c_f32_bf16 v251, v57, v57
  v_dot2c_f32_bf16 v250, s68, v58
  v_dot2c_f32_bf16 v251, v58, v58
  v_dot2c_f32_bf16 v250, s68, v59
  v_dot2c_f32_bf16 v251, v59, v59
  s_waitcnt lgkmcnt(4)
  v_dot2c_f32_bf16 v250, s68, v60
  v_dot2c_f32_bf16 v251, v60, v60
  v_dot2c_f32_bf16 v250, s68, v61
  v_dot2c_f32_bf16 v251, v61, v61
  v_dot2c_f32_bf16 v250, s68, v62
  v_dot2c_f32_bf16 v251, v62, v62
  v_dot2c_f32_bf16 v250, s68, v63
  v_dot2c_f32_bf16 v251, v63, v63
  v_lshlrev_b32 v11, 2, v12
  v_xor_b32 v11, v11, v13
  v_lshl_add_u32 v136, v11, 4, v14
  v_add_u32 v137, 6144, v136
  s_and_b32 s70, s3, 1
  s_lshl_b32 s70, s70, 12
  s_add_u32 s70, s70, 147456
  v_lshlrev_b32 v10, 7, v9
  v_lshl_add_u32 v10, v3, 3, v10
  v_add_u32 v10, s70, v10
  s_lshr_b32 s70, s3, 1
  s_lshl_b32 s71, s70, 2
  v_xor_b32 v13, s71, v13
  v_lshl_add_u32 v140, v13, 4, v10
  v_mad_u32_u24 v10, v3, 14, v15
  v_lshlrev_b32 v10, 7, v10
  v_bfe_u32 v13, v1, 3, 1
  v_xor_b32 v13, v13, v3
  v_xor_b32 v13, s70, v13
  v_lshl_add_u32 v10, v13, 6, v10
  v_lshl_add_u32 v10, v12, 5, v10
  v_lshl_add_u32 v10, v8, 3, v10
  s_mul_i32 s70, s70, 14336
  s_add_u32 s70, s70, 86016
  v_add_u32 v141, s70, v10
  v_lshl_add_u32 v11, v3, 3, v15
  v_lshlrev_b32 v11, 6, v11
  v_lshl_add_u32 v12, v12, 2, v8
  v_cmp_lt_u32 vcc, 5, v12
  s_add_u32 m0, s75, 24576
  s_add_u32 s72, s63, s46
  buffer_load_dwordx4 v244, s[8:11], s72 offen offset:0 lds
  buffer_load_dwordx4 v245, s[8:11], s72 offen offset:1024 lds
  buffer_load_dwordx4 v246, s[8:11], s72 offen offset:2048 lds
  buffer_load_dwordx4 v247, s[8:11], s72 offen offset:3072 lds
  s_waitcnt vmcnt(8)
  ds_read_b128 v[80:83], v240 offset:16384
  ds_read_b128 v[84:87], v241 offset:16384
  ds_read_b128 v[88:91], v242 offset:16384
  ds_read_b128 v[92:95], v243 offset:16384
  s_waitcnt lgkmcnt(7)
  v_dot2c_f32_bf16 v250, s68, v64
  v_dot2c_f32_bf16 v251, v64, v64
  v_dot2c_f32_bf16 v250, s68, v65
  v_dot2c_f32_bf16 v251, v65, v65
  v_dot2c_f32_bf16 v250, s68, v66
  v_dot2c_f32_bf16 v251, v66, v66
  v_dot2c_f32_bf16 v250, s68, v67
  v_dot2c_f32_bf16 v251, v67, v67
  s_waitcnt lgkmcnt(6)
  v_dot2c_f32_bf16 v250, s68, v68
  v_dot2c_f32_bf16 v251, v68, v68
  v_dot2c_f32_bf16 v250, s68, v69
  v_dot2c_f32_bf16 v251, v69, v69
  v_dot2c_f32_bf16 v250, s68, v70
  v_dot2c_f32_bf16 v251, v70, v70
  v_dot2c_f32_bf16 v250, s68, v71
  v_dot2c_f32_bf16 v251, v71, v71
  s_waitcnt lgkmcnt(5)
  v_dot2c_f32_bf16 v250, s68, v72
  v_dot2c_f32_bf16 v251, v72, v72
  v_dot2c_f32_bf16 v250, s68, v73
  v_dot2c_f32_bf16 v251, v73, v73
  v_dot2c_f32_bf16 v250, s68, v74
  v_dot2c_f32_bf16 v251, v74, v74
  v_dot2c_f32_bf16 v250, s68, v75
  v_dot2c_f32_bf16 v251, v75, v75
  s_waitcnt lgkmcnt(4)
  v_dot2c_f32_bf16 v250, s68, v76
  v_dot2c_f32_bf16 v251, v76, v76
  v_dot2c_f32_bf16 v250, s68, v77
  v_dot2c_f32_bf16 v251, v77, v77
  v_dot2c_f32_bf16 v250, s68, v78
  v_dot2c_f32_bf16 v251, v78, v78
  v_dot2c_f32_bf16 v250, s68, v79
  v_dot2c_f32_bf16 v251, v79, v79
  v_xor_b32 v13, 1, v12
  v_cndmask_b32 v12, v12, v13, vcc
  v_lshl_add_u32 v11, v12, 3, v11
  v_add_u32 v13, 57344, v11
  v_bfe_u32 v10, v1, 2, 1
  v_bfe_u32 v14, v1, 4, 1
  v_lshl_add_u32 v10, v14, 1, v10
  v_cmp_eq_u32 vcc, v10, v3
  v_and_b32 v10, 1, v1
  v_lshlrev_b32 v10, 4, v10
  v_mov_b32 v14, 0x3f80
  v_lshlrev_b32 v10, v10, v14
  v_cndmask_b32 v10, 0, v10, vcc
  v_bfe_u32 v14, v1, 3, 1
  v_bfe_u32 v15, v1, 1, 1
  v_lshl_add_u32 v14, v14, 1, v15
  v_cmp_eq_u32 vcc, 0, v14
  s_nop 1
  v_cndmask_b32 v15, 0, v10, vcc
  v_accvgpr_write_b32 a220, v15
  v_cmp_eq_u32 vcc, 1, v14
  s_nop 1
  v_cndmask_b32 v15, 0, v10, vcc
  v_accvgpr_write_b32 a221, v15
  v_cmp_eq_u32 vcc, 2, v14
  s_nop 1
  v_cndmask_b32 v15, 0, v10, vcc
  v_accvgpr_write_b32 a222, v15
  v_cmp_eq_u32 vcc, 3, v14
  s_nop 1
  v_cndmask_b32 v15, 0, v10, vcc
  v_accvgpr_write_b32 a223, v15
  v_add_u32 v9, 896, v7
  s_add_u32 m0, s82, 57344
  s_add_u32 s72, s76, s47
  buffer_load_dwordx4 v7, s[12:15], s72 offen offset:0 lds
  s_waitcnt vmcnt(5)
  ds_read_b128 v[96:99], v240 offset:20480
  ds_read_b128 v[100:103], v241 offset:20480
  ds_read_b128 v[104:107], v242 offset:20480
  ds_read_b128 v[108:111], v243 offset:20480
  s_waitcnt lgkmcnt(7)
  v_dot2c_f32_bf16 v250, s68, v80
  v_dot2c_f32_bf16 v251, v80, v80
  v_dot2c_f32_bf16 v250, s68, v81
  v_dot2c_f32_bf16 v251, v81, v81
  v_dot2c_f32_bf16 v250, s68, v82
  v_dot2c_f32_bf16 v251, v82, v82
  v_dot2c_f32_bf16 v250, s68, v83
  v_dot2c_f32_bf16 v251, v83, v83
  s_waitcnt lgkmcnt(6)
  v_dot2c_f32_bf16 v250, s68, v84
  v_dot2c_f32_bf16 v251, v84, v84
  v_dot2c_f32_bf16 v250, s68, v85
  v_dot2c_f32_bf16 v251, v85, v85
  v_dot2c_f32_bf16 v250, s68, v86
  v_dot2c_f32_bf16 v251, v86, v86
  v_dot2c_f32_bf16 v250, s68, v87
  v_dot2c_f32_bf16 v251, v87, v87
  s_waitcnt lgkmcnt(5)
  v_dot2c_f32_bf16 v250, s68, v88
  v_dot2c_f32_bf16 v251, v88, v88
  v_dot2c_f32_bf16 v250, s68, v89
  v_dot2c_f32_bf16 v251, v89, v89
  v_dot2c_f32_bf16 v250, s68, v90
  v_dot2c_f32_bf16 v251, v90, v90
  v_dot2c_f32_bf16 v250, s68, v91
  v_dot2c_f32_bf16 v251, v91, v91
  s_waitcnt lgkmcnt(4)
  v_dot2c_f32_bf16 v250, s68, v92
  v_dot2c_f32_bf16 v251, v92, v92
  v_dot2c_f32_bf16 v250, s68, v93
  v_dot2c_f32_bf16 v251, v93, v93
  v_dot2c_f32_bf16 v250, s68, v94
  v_dot2c_f32_bf16 v251, v94, v94
  v_dot2c_f32_bf16 v250, s68, v95
  v_dot2c_f32_bf16 v251, v95, v95
  s_add_u32 m0, s82, 61440
  s_add_u32 s72, s76, s48
  buffer_load_dwordx4 v7, s[12:15], s72 offen offset:0 lds
  s_waitcnt vmcnt(2)
  ds_read_b128 v[112:115], v240 offset:24576
  ds_read_b128 v[116:119], v241 offset:24576
  ds_read_b128 v[120:123], v242 offset:24576
  ds_read_b128 v[124:127], v243 offset:24576
  s_waitcnt lgkmcnt(7)
  v_dot2c_f32_bf16 v250, s68, v96
  v_dot2c_f32_bf16 v251, v96, v96
  v_dot2c_f32_bf16 v250, s68, v97
  v_dot2c_f32_bf16 v251, v97, v97
  v_dot2c_f32_bf16 v250, s68, v98
  v_dot2c_f32_bf16 v251, v98, v98
  v_dot2c_f32_bf16 v250, s68, v99
  v_dot2c_f32_bf16 v251, v99, v99
  s_waitcnt lgkmcnt(6)
  v_dot2c_f32_bf16 v250, s68, v100
  v_dot2c_f32_bf16 v251, v100, v100
  v_dot2c_f32_bf16 v250, s68, v101
  v_dot2c_f32_bf16 v251, v101, v101
  v_dot2c_f32_bf16 v250, s68, v102
  v_dot2c_f32_bf16 v251, v102, v102
  v_dot2c_f32_bf16 v250, s68, v103
  v_dot2c_f32_bf16 v251, v103, v103
  s_waitcnt lgkmcnt(5)
  v_dot2c_f32_bf16 v250, s68, v104
  v_dot2c_f32_bf16 v251, v104, v104
  v_dot2c_f32_bf16 v250, s68, v105
  v_dot2c_f32_bf16 v251, v105, v105
  v_dot2c_f32_bf16 v250, s68, v106
  v_dot2c_f32_bf16 v251, v106, v106
  v_dot2c_f32_bf16 v250, s68, v107
  v_dot2c_f32_bf16 v251, v107, v107
  s_waitcnt lgkmcnt(4)
  v_dot2c_f32_bf16 v250, s68, v108
  v_dot2c_f32_bf16 v251, v108, v108
  v_dot2c_f32_bf16 v250, s68, v109
  v_dot2c_f32_bf16 v251, v109, v109
  v_dot2c_f32_bf16 v250, s68, v110
  v_dot2c_f32_bf16 v251, v110, v110
  v_dot2c_f32_bf16 v250, s68, v111
  v_dot2c_f32_bf16 v251, v111, v111
  s_add_u32 m0, s82, 65536
  s_add_u32 s72, s76, s49
  buffer_load_dwordx4 v7, s[12:15], s72 offen offset:0 lds
  s_waitcnt lgkmcnt(3)
  v_dot2c_f32_bf16 v250, s68, v112
  v_dot2c_f32_bf16 v251, v112, v112
  v_dot2c_f32_bf16 v250, s68, v113
  v_dot2c_f32_bf16 v251, v113, v113
  v_dot2c_f32_bf16 v250, s68, v114
  v_dot2c_f32_bf16 v251, v114, v114
  v_dot2c_f32_bf16 v250, s68, v115
  v_dot2c_f32_bf16 v251, v115, v115
  s_waitcnt lgkmcnt(2)
  v_dot2c_f32_bf16 v250, s68, v116
  v_dot2c_f32_bf16 v251, v116, v116
  v_dot2c_f32_bf16 v250, s68, v117
  v_dot2c_f32_bf16 v251, v117, v117
  v_dot2c_f32_bf16 v250, s68, v118
  v_dot2c_f32_bf16 v251, v118, v118
  v_dot2c_f32_bf16 v250, s68, v119
  v_dot2c_f32_bf16 v251, v119, v119
  s_waitcnt lgkmcnt(1)
  v_dot2c_f32_bf16 v250, s68, v120
  v_dot2c_f32_bf16 v251, v120, v120
  v_dot2c_f32_bf16 v250, s68, v121
  v_dot2c_f32_bf16 v251, v121, v121
  v_dot2c_f32_bf16 v250, s68, v122
  v_dot2c_f32_bf16 v251, v122, v122
  v_dot2c_f32_bf16 v250, s68, v123
  v_dot2c_f32_bf16 v251, v123, v123
  s_waitcnt lgkmcnt(0)
  v_dot2c_f32_bf16 v250, s68, v124
  v_dot2c_f32_bf16 v251, v124, v124
  v_dot2c_f32_bf16 v250, s68, v125
  v_dot2c_f32_bf16 v251, v125, v125
  v_dot2c_f32_bf16 v250, s68, v126
  v_dot2c_f32_bf16 v251, v126, v126
  v_dot2c_f32_bf16 v250, s68, v127
  v_dot2c_f32_bf16 v251, v127, v127
  s_nop 2
  v_permlane32_swap_b32 v250, v251
  v_readfirstlane_b32 s70, v5
  s_nop 0
  v_add_f32 v250, v250, v251
  v_mul_f32 v250, 0xbb124925, v250
  v_mov_b32 v251, v250
  s_or_b32 s70, s70, 1
  s_mul_i32 s70, s70, 0x9E3779B5
  v_mov_b32 v5, s70
  s_mov_b32 s70, 0x3f80
  v_permlane32_swap_b32 v250, v251
  s_mov_b32 s71, 0x3f800000
  s_add_u32 m0, s82, 69632
  s_add_u32 s72, s76, s50
  s_nop 0
  buffer_load_dwordx4 v7, s[12:15], s72 offen offset:0 lds
  v_dot2_f32_bf16 v232, v16, s70, v250
  v_dot2_f32_bf16 v233, v16, s71, v250
  v_dot2_f32_bf16 v234, v17, s70, v250
  v_dot2_f32_bf16 v235, v17, s71, v250
  v_dot2_f32_bf16 v236, v18, s70, v250
  v_dot2_f32_bf16 v237, v18, s71, v250
  v_dot2_f32_bf16 v238, v19, s70, v250
  v_dot2_f32_bf16 v239, v19, s71, v250
  v_dot2_f32_bf16 v240, v20, s70, v250
  v_dot2_f32_bf16 v241, v20, s71, v250
  v_dot2_f32_bf16 v242, v21, s70, v250
  v_dot2_f32_bf16 v243, v21, s71, v250
  v_dot2_f32_bf16 v244, v22, s70, v250
  v_dot2_f32_bf16 v245, v22, s71, v250
  v_dot2_f32_bf16 v246, v23, s70, v250
  v_dot2_f32_bf16 v247, v23, s71, v250
  v_cvt_pk_bf16_f32 v16, v232, v233
  v_cvt_pk_bf16_f32 v17, v234, v235
  v_cvt_pk_bf16_f32 v18, v236, v237
  v_cvt_pk_bf16_f32 v19, v238, v239
  v_dot2_f32_bf16 v232, v24, s70, v250
  v_dot2_f32_bf16 v233, v24, s71, v250
  v_dot2_f32_bf16 v234, v25, s70, v250
  v_dot2_f32_bf16 v235, v25, s71, v250
  v_dot2_f32_bf16 v236, v26, s70, v250
  v_dot2_f32_bf16 v237, v26, s71, v250
  v_dot2_f32_bf16 v238, v27, s70, v250
  v_dot2_f32_bf16 v239, v27, s71, v250
  v_cvt_pk_bf16_f32 v20, v240, v241
  v_cvt_pk_bf16_f32 v21, v242, v243
  s_add_u32 m0, s82, 73728
  s_add_u32 s72, s76, s51
  s_nop 0
  buffer_load_dwordx4 v7, s[12:15], s72 offen offset:0 lds
  v_cvt_pk_bf16_f32 v22, v244, v245
  v_cvt_pk_bf16_f32 v23, v246, v247
  v_dot2_f32_bf16 v240, v28, s70, v250
  v_dot2_f32_bf16 v241, v28, s71, v250
  v_dot2_f32_bf16 v242, v29, s70, v250
  v_dot2_f32_bf16 v243, v29, s71, v250
  v_dot2_f32_bf16 v244, v30, s70, v250
  v_dot2_f32_bf16 v245, v30, s71, v250
  v_dot2_f32_bf16 v246, v31, s70, v250
  v_dot2_f32_bf16 v247, v31, s71, v250
  v_cvt_pk_bf16_f32 v24, v232, v233
  v_cvt_pk_bf16_f32 v25, v234, v235
  v_cvt_pk_bf16_f32 v26, v236, v237
  v_cvt_pk_bf16_f32 v27, v238, v239
  v_dot2_f32_bf16 v232, v32, s70, v250
  v_dot2_f32_bf16 v233, v32, s71, v250
  v_dot2_f32_bf16 v234, v33, s70, v250
  v_dot2_f32_bf16 v235, v33, s71, v250
  v_dot2_f32_bf16 v236, v34, s70, v250
  v_dot2_f32_bf16 v237, v34, s71, v250
  v_dot2_f32_bf16 v238, v35, s70, v250
  v_dot2_f32_bf16 v239, v35, s71, v250
  v_cvt_pk_bf16_f32 v28, v240, v241
  v_cvt_pk_bf16_f32 v29, v242, v243
  v_cvt_pk_bf16_f32 v30, v244, v245
  v_cvt_pk_bf16_f32 v31, v246, v247
  v_dot2_f32_bf16 v240, v36, s70, v250
  v_dot2_f32_bf16 v241, v36, s71, v250
  v_dot2_f32_bf16 v242, v37, s70, v250
  v_dot2_f32_bf16 v243, v37, s71, v250
  s_add_u32 m0, s82, 77824
  s_add_u32 s72, s76, s52
  s_nop 0
  buffer_load_dwordx4 v7, s[12:15], s72 offen offset:0 lds
  v_dot2_f32_bf16 v244, v38, s70, v250
  v_dot2_f32_bf16 v245, v38, s71, v250
  v_dot2_f32_bf16 v246, v39, s70, v250
  v_dot2_f32_bf16 v247, v39, s71, v250
  v_cvt_pk_bf16_f32 v32, v232, v233
  v_cvt_pk_bf16_f32 v33, v234, v235
  v_cvt_pk_bf16_f32 v34, v236, v237
  v_cvt_pk_bf16_f32 v35, v238, v239
  v_dot2_f32_bf16 v232, v40, s70, v250
  v_dot2_f32_bf16 v233, v40, s71, v250
  v_dot2_f32_bf16 v234, v41, s70, v250
  v_dot2_f32_bf16 v235, v41, s71, v250
  v_dot2_f32_bf16 v236, v42, s70, v250
  v_dot2_f32_bf16 v237, v42, s71, v250
  v_dot2_f32_bf16 v238, v43, s70, v250
  v_dot2_f32_bf16 v239, v43, s71, v250
  v_cvt_pk_bf16_f32 v36, v240, v241
  v_cvt_pk_bf16_f32 v37, v242, v243
  v_cvt_pk_bf16_f32 v38, v244, v245
  v_cvt_pk_bf16_f32 v39, v246, v247
  v_dot2_f32_bf16 v240, v44, s70, v250
  v_dot2_f32_bf16 v241, v44, s71, v250
  v_dot2_f32_bf16 v242, v45, s70, v250
  v_dot2_f32_bf16 v243, v45, s71, v250
  v_dot2_f32_bf16 v244, v46, s70, v250
  v_dot2_f32_bf16 v245, v46, s71, v250
  v_dot2_f32_bf16 v246, v47, s70, v250
  v_dot2_f32_bf16 v247, v47, s71, v250
  v_cvt_pk_bf16_f32 v40, v232, v233
  v_cvt_pk_bf16_f32 v41, v234, v235
  s_add_u32 m0, s82, 81920
  s_add_u32 s72, s76, s53
  s_nop 0
  buffer_load_dwordx4 v7, s[12:15], s72 offen offset:0 lds
  v_cvt_pk_bf16_f32 v42, v236, v237
  v_cvt_pk_bf16_f32 v43, v238, v239
  v_dot2_f32_bf16 v232, v48, s70, v250
  v_dot2_f32_bf16 v233, v48, s71, v250
  v_dot2_f32_bf16 v234, v49, s70, v250
  v_dot2_f32_bf16 v235, v49, s71, v250
  v_dot2_f32_bf16 v236, v50, s70, v250
  v_dot2_f32_bf16 v237, v50, s71, v250
  v_dot2_f32_bf16 v238, v51, s70, v250
  v_dot2_f32_bf16 v239, v51, s71, v250
  s_barrier
  s_nop 0
  v_cvt_pk_bf16_f32 v44, v240, v241
  v_cvt_pk_bf16_f32 v45, v242, v243
  v_cvt_pk_bf16_f32 v46, v244, v245
  v_cvt_pk_bf16_f32 v47, v246, v247
  v_dot2_f32_bf16 v240, v52, s70, v250
  v_dot2_f32_bf16 v241, v52, s71, v250
  v_dot2_f32_bf16 v242, v53, s70, v250
  v_dot2_f32_bf16 v243, v53, s71, v250
  v_dot2_f32_bf16 v244, v54, s70, v250
  v_dot2_f32_bf16 v245, v54, s71, v250
  v_dot2_f32_bf16 v246, v55, s70, v250
  v_dot2_f32_bf16 v247, v55, s71, v250
  v_cvt_pk_bf16_f32 v48, v232, v233
  v_cvt_pk_bf16_f32 v49, v234, v235
  v_cvt_pk_bf16_f32 v50, v236, v237
  v_cvt_pk_bf16_f32 v51, v238, v239
  v_dot2_f32_bf16 v232, v56, s70, v250
  v_dot2_f32_bf16 v233, v56, s71, v250
  v_dot2_f32_bf16 v234, v57, s70, v250
  v_dot2_f32_bf16 v235, v57, s71, v250
  v_dot2_f32_bf16 v236, v58, s70, v250
  v_dot2_f32_bf16 v237, v58, s71, v250
  v_dot2_f32_bf16 v238, v59, s70, v250
  v_dot2_f32_bf16 v239, v59, s71, v250
  v_cvt_pk_bf16_f32 v52, v240, v241
  v_cvt_pk_bf16_f32 v53, v242, v243
  v_cvt_pk_bf16_f32 v54, v244, v245
  v_cvt_pk_bf16_f32 v55, v246, v247
  v_dot2_f32_bf16 v240, v60, s70, v250
  v_dot2_f32_bf16 v241, v60, s71, v250
  s_add_u32 m0, s82, 0
  s_add_u32 s72, s76, s47
  buffer_load_dwordx4 v9, s[12:15], s72 offen offset:0 lds
  v_dot2_f32_bf16 v242, v61, s70, v250
  v_dot2_f32_bf16 v243, v61, s71, v250
  v_dot2_f32_bf16 v244, v62, s70, v250
  v_dot2_f32_bf16 v245, v62, s71, v250
  v_dot2_f32_bf16 v246, v63, s70, v250
  v_dot2_f32_bf16 v247, v63, s71, v250
  v_cvt_pk_bf16_f32 v56, v232, v233
  v_cvt_pk_bf16_f32 v57, v234, v235
  v_cvt_pk_bf16_f32 v58, v236, v237
  v_cvt_pk_bf16_f32 v59, v238, v239
  v_dot2_f32_bf16 v232, v64, s70, v250
  v_dot2_f32_bf16 v233, v64, s71, v250
  v_dot2_f32_bf16 v234, v65, s70, v250
  v_dot2_f32_bf16 v235, v65, s71, v250
  v_dot2_f32_bf16 v236, v66, s70, v250
  v_dot2_f32_bf16 v237, v66, s71, v250
  v_dot2_f32_bf16 v238, v67, s70, v250
  v_dot2_f32_bf16 v239, v67, s71, v250
  v_cvt_pk_bf16_f32 v60, v240, v241
  v_cvt_pk_bf16_f32 v61, v242, v243
  v_cvt_pk_bf16_f32 v62, v244, v245
  v_cvt_pk_bf16_f32 v63, v246, v247
  v_dot2_f32_bf16 v240, v68, s70, v250
  v_dot2_f32_bf16 v241, v68, s71, v250
  v_dot2_f32_bf16 v242, v69, s70, v250
  v_dot2_f32_bf16 v243, v69, s71, v250
  v_dot2_f32_bf16 v244, v70, s70, v250
  v_dot2_f32_bf16 v245, v70, s71, v250
  v_dot2_f32_bf16 v246, v71, s70, v250
  v_dot2_f32_bf16 v247, v71, s71, v250
  v_cvt_pk_bf16_f32 v64, v232, v233
  v_cvt_pk_bf16_f32 v65, v234, v235
  v_cvt_pk_bf16_f32 v66, v236, v237
  v_cvt_pk_bf16_f32 v67, v238, v239
  v_dot2_f32_bf16 v232, v72, s70, v250
  v_dot2_f32_bf16 v233, v72, s71, v250
  v_dot2_f32_bf16 v234, v73, s70, v250
  v_dot2_f32_bf16 v235, v73, s71, v250
  v_dot2_f32_bf16 v236, v74, s70, v250
  v_dot2_f32_bf16 v237, v74, s71, v250
  v_dot2_f32_bf16 v238, v75, s70, v250
  v_dot2_f32_bf16 v239, v75, s71, v250
  v_cvt_pk_bf16_f32 v68, v240, v241
  v_cvt_pk_bf16_f32 v69, v242, v243
  v_cvt_pk_bf16_f32 v70, v244, v245
  v_cvt_pk_bf16_f32 v71, v246, v247
  v_dot2_f32_bf16 v240, v76, s70, v250
  v_dot2_f32_bf16 v241, v76, s71, v250
  v_dot2_f32_bf16 v242, v77, s70, v250
  v_dot2_f32_bf16 v243, v77, s71, v250
  s_add_u32 m0, s82, 4096
  s_add_u32 s72, s76, s48
  s_nop 0
  buffer_load_dwordx4 v9, s[12:15], s72 offen offset:0 lds
  v_dot2_f32_bf16 v244, v78, s70, v250
  v_dot2_f32_bf16 v245, v78, s71, v250
  v_dot2_f32_bf16 v246, v79, s70, v250
  v_dot2_f32_bf16 v247, v79, s71, v250
  v_cvt_pk_bf16_f32 v72, v232, v233
  v_cvt_pk_bf16_f32 v73, v234, v235
  v_cvt_pk_bf16_f32 v74, v236, v237
  v_cvt_pk_bf16_f32 v75, v238, v239
  v_dot2_f32_bf16 v232, v80, s70, v250
  v_dot2_f32_bf16 v233, v80, s71, v250
  v_dot2_f32_bf16 v234, v81, s70, v250
  v_dot2_f32_bf16 v235, v81, s71, v250
  v_dot2_f32_bf16 v236, v82, s70, v250
  v_dot2_f32_bf16 v237, v82, s71, v250
  v_dot2_f32_bf16 v238, v83, s70, v250
  v_dot2_f32_bf16 v239, v83, s71, v250
  v_cvt_pk_bf16_f32 v76, v240, v241
  v_cvt_pk_bf16_f32 v77, v242, v243
  v_cvt_pk_bf16_f32 v78, v244, v245
  v_cvt_pk_bf16_f32 v79, v246, v247
  v_dot2_f32_bf16 v240, v84, s70, v250
  v_dot2_f32_bf16 v241, v84, s71, v250
  v_dot2_f32_bf16 v242, v85, s70, v250
  v_dot2_f32_bf16 v243, v85, s71, v250
  v_dot2_f32_bf16 v244, v86, s70, v250
  v_dot2_f32_bf16 v245, v86, s71, v250
  v_dot2_f32_bf16 v246, v87, s70, v250
  v_dot2_f32_bf16 v247, v87, s71, v250
  v_cvt_pk_bf16_f32 v80, v232, v233
  v_cvt_pk_bf16_f32 v81, v234, v235
  v_cvt_pk_bf16_f32 v82, v236, v237
  v_cvt_pk_bf16_f32 v83, v238, v239
  v_dot2_f32_bf16 v232, v88, s70, v250
  v_dot2_f32_bf16 v233, v88, s71, v250
  v_dot2_f32_bf16 v234, v89, s70, v250
  v_dot2_f32_bf16 v235, v89, s71, v250
  v_dot2_f32_bf16 v236, v90, s70, v250
  v_dot2_f32_bf16 v237, v90, s71, v250
  v_dot2_f32_bf16 v238, v91, s70, v250
  v_dot2_f32_bf16 v239, v91, s71, v250
  v_cvt_pk_bf16_f32 v84, v240, v241
  v_cvt_pk_bf16_f32 v85, v242, v243
  v_cvt_pk_bf16_f32 v86, v244, v245
  v_cvt_pk_bf16_f32 v87, v246, v247
  v_dot2_f32_bf16 v240, v92, s70, v250
  v_dot2_f32_bf16 v241, v92, s71, v250
  v_dot2_f32_bf16 v242, v93, s70, v250
  v_dot2_f32_bf16 v243, v93, s71, v250
  v_dot2_f32_bf16 v244, v94, s70, v250
  v_dot2_f32_bf16 v245, v94, s71, v250
  s_add_u32 m0, s82, 8192
  s_add_u32 s72, s76, s49
  s_nop 0
  buffer_load_dwordx4 v9, s[12:15], s72 offen offset:0 lds
  v_dot2_f32_bf16 v246, v95, s70, v250
  v_dot2_f32_bf16 v247, v95, s71, v250
  v_cvt_pk_bf16_f32 v88, v232, v233
  v_cvt_pk_bf16_f32 v89, v234, v235
  v_cvt_pk_bf16_f32 v90, v236, v237
  v_cvt_pk_bf16_f32 v91, v238, v239
  v_dot2_f32_bf16 v232, v96, s70, v250
  v_dot2_f32_bf16 v233, v96, s71, v250
  v_dot2_f32_bf16 v234, v97, s70, v250
  v_dot2_f32_bf16 v235, v97, s71, v250
  v_dot2_f32_bf16 v236, v98, s70, v250
  v_dot2_f32_bf16 v237, v98, s71, v250
  v_dot2_f32_bf16 v238, v99, s70, v250
  v_dot2_f32_bf16 v239, v99, s71, v250
  v_cvt_pk_bf16_f32 v92, v240, v241
  v_cvt_pk_bf16_f32 v93, v242, v243
  v_cvt_pk_bf16_f32 v94, v244, v245
  v_cvt_pk_bf16_f32 v95, v246, v247
  v_dot2_f32_bf16 v240, v100, s70, v250
  v_dot2_f32_bf16 v241, v100, s71, v250
  v_dot2_f32_bf16 v242, v101, s70, v250
  v_dot2_f32_bf16 v243, v101, s71, v250
  v_dot2_f32_bf16 v244, v102, s70, v250
  v_dot2_f32_bf16 v245, v102, s71, v250
  v_dot2_f32_bf16 v246, v103, s70, v250
  v_dot2_f32_bf16 v247, v103, s71, v250
  v_cvt_pk_bf16_f32 v96, v232, v233
  v_cvt_pk_bf16_f32 v97, v234, v235
  v_cvt_pk_bf16_f32 v98, v236, v237
  v_cvt_pk_bf16_f32 v99, v238, v239
  v_dot2_f32_bf16 v232, v104, s70, v250
  v_dot2_f32_bf16 v233, v104, s71, v250
  v_dot2_f32_bf16 v234, v105, s70, v250
  v_dot2_f32_bf16 v235, v105, s71, v250
  v_dot2_f32_bf16 v236, v106, s70, v250
  v_dot2_f32_bf16 v237, v106, s71, v250
  v_dot2_f32_bf16 v238, v107, s70, v250
  v_dot2_f32_bf16 v239, v107, s71, v250
  v_cvt_pk_bf16_f32 v100, v240, v241
  v_cvt_pk_bf16_f32 v101, v242, v243
  v_cvt_pk_bf16_f32 v102, v244, v245
  v_cvt_pk_bf16_f32 v103, v246, v247
  v_dot2_f32_bf16 v240, v108, s70, v250
  v_dot2_f32_bf16 v241, v108, s71, v250
  v_dot2_f32_bf16 v242, v109, s70, v250
  v_dot2_f32_bf16 v243, v109, s71, v250
  v_dot2_f32_bf16 v244, v110, s70, v250
  v_dot2_f32_bf16 v245, v110, s71, v250
  v_dot2_f32_bf16 v246, v111, s70, v250
  v_dot2_f32_bf16 v247, v111, s71, v250
  s_add_u32 m0, s82, 12288
  s_add_u32 s72, s76, s50
  s_nop 0
  buffer_load_dwordx4 v9, s[12:15], s72 offen offset:0 lds
  v_cvt_pk_bf16_f32 v104, v232, v233
  v_cvt_pk_bf16_f32 v105, v234, v235
  v_cvt_pk_bf16_f32 v106, v236, v237
  v_cvt_pk_bf16_f32 v107, v238, v239
  v_dot2_f32_bf16 v232, v112, s70, v250
  v_dot2_f32_bf16 v233, v112, s71, v250
  v_dot2_f32_bf16 v234, v113, s70, v250
  v_dot2_f32_bf16 v235, v113, s71, v250
  v_dot2_f32_bf16 v236, v114, s70, v250
  v_dot2_f32_bf16 v237, v114, s71, v250
  v_dot2_f32_bf16 v238, v115, s70, v250
  v_dot2_f32_bf16 v239, v115, s71, v250
  v_cvt_pk_bf16_f32 v108, v240, v241
  v_cvt_pk_bf16_f32 v109, v242, v243
  v_cvt_pk_bf16_f32 v110, v244, v245
  v_cvt_pk_bf16_f32 v111, v246, v247
  v_dot2_f32_bf16 v240, v116, s70, v250
  v_dot2_f32_bf16 v241, v116, s71, v250
  v_dot2_f32_bf16 v242, v117, s70, v250
  v_dot2_f32_bf16 v243, v117, s71, v250
  v_dot2_f32_bf16 v244, v118, s70, v250
  v_dot2_f32_bf16 v245, v118, s71, v250
  v_dot2_f32_bf16 v246, v119, s70, v250
  v_dot2_f32_bf16 v247, v119, s71, v250
  v_cvt_pk_bf16_f32 v112, v232, v233
  v_cvt_pk_bf16_f32 v113, v234, v235
  v_cvt_pk_bf16_f32 v114, v236, v237
  v_cvt_pk_bf16_f32 v115, v238, v239
  v_dot2_f32_bf16 v232, v120, s70, v250
  v_dot2_f32_bf16 v233, v120, s71, v250
  v_dot2_f32_bf16 v234, v121, s70, v250
  v_dot2_f32_bf16 v235, v121, s71, v250
  v_dot2_f32_bf16 v236, v122, s70, v250
  v_dot2_f32_bf16 v237, v122, s71, v250
  v_dot2_f32_bf16 v238, v123, s70, v250
  v_dot2_f32_bf16 v239, v123, s71, v250
  v_cvt_pk_bf16_f32 v116, v240, v241
  v_cvt_pk_bf16_f32 v117, v242, v243
  v_cvt_pk_bf16_f32 v118, v244, v245
  v_cvt_pk_bf16_f32 v119, v246, v247
  v_dot2_f32_bf16 v240, v124, s70, v250
  v_dot2_f32_bf16 v241, v124, s71, v250
  v_dot2_f32_bf16 v242, v125, s70, v250
  v_dot2_f32_bf16 v243, v125, s71, v250
  v_dot2_f32_bf16 v244, v126, s70, v250
  v_dot2_f32_bf16 v245, v126, s71, v250
  v_dot2_f32_bf16 v246, v127, s70, v250
  v_dot2_f32_bf16 v247, v127, s71, v250
  v_cvt_pk_bf16_f32 v120, v232, v233
  v_cvt_pk_bf16_f32 v121, v234, v235
  v_cvt_pk_bf16_f32 v122, v236, v237
  v_cvt_pk_bf16_f32 v123, v238, v239
  v_cvt_pk_bf16_f32 v124, v240, v241
  v_cvt_pk_bf16_f32 v125, v242, v243
  v_cvt_pk_bf16_f32 v126, v244, v245
  v_cvt_pk_bf16_f32 v127, v246, v247
  s_waitcnt vmcnt(4)
  s_barrier
  ds_read_b64_tr_b16 a[224:225], v13 offset:0
  ds_read_b64_tr_b16 a[226:227], v13 offset:256
  ds_read_b64_tr_b16 a[228:229], v13 offset:1024
  ds_read_b64_tr_b16 a[230:231], v13 offset:1280
  ds_read_b64_tr_b16 a[232:233], v13 offset:2048
  ds_read_b64_tr_b16 a[234:235], v13 offset:2304
  ds_read_b64_tr_b16 a[236:237], v13 offset:3072
  ds_read_b64_tr_b16 a[238:239], v13 offset:3328
  ds_read_b64_tr_b16 a[240:241], v13 offset:4096
  ds_read_b64_tr_b16 a[242:243], v13 offset:4352
  ds_read_b64_tr_b16 a[244:245], v13 offset:5120
  ds_read_b64_tr_b16 a[246:247], v13 offset:5376
  s_waitcnt lgkmcnt(8)
  v_mfma_f32_32x32x16_bf16 v[144:159], a[224:227], v[16:19], 0
  ds_read_b64_tr_b16 a[248:249], v13 offset:6144
  ds_read_b64_tr_b16 a[250:251], v13 offset:6400
  s_add_u32 m0, s82, 16384
  s_add_u32 s72, s76, s51
  buffer_load_dwordx4 v9, s[12:15], s72 offen offset:0 lds
  v_mfma_f32_32x32x16_bf16 v[144:159], a[228:231], v[20:23], v[144:159]
  ds_read_b64_tr_b16 a[252:253], v13 offset:7168
  ds_read_b64_tr_b16 a[254:255], v13 offset:7424
  s_waitcnt lgkmcnt(8)
  v_mfma_f32_32x32x16_bf16 v[144:159], a[232:235], v[24:27], v[144:159]
  ds_read_b64_tr_b16 a[224:225], v13 offset:8192
  ds_read_b64_tr_b16 a[226:227], v13 offset:8448
  s_cmp_ge_u32 s74, 14
  s_cselect_b32 s22, 0, s22
  v_mfma_f32_32x32x16_bf16 v[144:159], a[236:239], v[28:31], v[144:159]
  ds_read_b64_tr_b16 a[228:229], v13 offset:9216
  ds_read_b64_tr_b16 a[230:231], v13 offset:9472
  v_fma_f32 v251, -v250, v250, -v251
  v_max_f32 v251, 0, v251
  s_waitcnt lgkmcnt(8)
  v_mfma_f32_32x32x16_bf16 v[144:159], a[240:243], v[32:35], v[144:159]
  ds_read_b64_tr_b16 a[232:233], v13 offset:10240
  ds_read_b64_tr_b16 a[234:235], v13 offset:10496
  v_add_f32 v251, 0x3727c5ac, v251
  v_rsq_f32 v251, v251
  v_mfma_f32_32x32x16_bf16 v[144:159], a[244:247], v[36:39], v[144:159]
  ds_read_b64_tr_b16 a[236:237], v13 offset:11264
  ds_read_b64_tr_b16 a[238:239], v13 offset:11520
  s_add_u32 m0, s82, 20480
  s_add_u32 s72, s76, s52
  buffer_load_dwordx4 v9, s[12:15], s72 offen offset:0 lds
  s_lshl_b32 s63, s61, 7
  s_mul_i32 s73, s3, 14336
  s_waitcnt lgkmcnt(8)
  v_mfma_f32_32x32x16_bf16 v[144:159], a[248:251], v[40:43], v[144:159]
  ds_read_b64_tr_b16 a[240:241], v13 offset:12288
  ds_read_b64_tr_b16 a[242:243], v13 offset:12544
  v_mul_f32 v252, 0x3fb8aa3b, v251
  v_mfma_f32_32x32x16_bf16 v[144:159], a[252:255], v[44:47], v[144:159]
  ds_read_b64_tr_b16 a[244:245], v13 offset:13312
  ds_read_b64_tr_b16 a[246:247], v13 offset:13568
  v_mul_f32 v253, 0xbfb8aa3b, v251
  s_add_u32 s63, s63, s73
  s_waitcnt lgkmcnt(8)
  v_mfma_f32_32x32x16_bf16 v[144:159], a[224:227], v[48:51], v[144:159]
  ds_read_b64_tr_b16 a[248:249], v13 offset:14336
  ds_read_b64_tr_b16 a[250:251], v13 offset:14592
  s_lshl_b32 s75, s3, 11
  s_lshl_b32 s40, s7, 8
  v_mfma_f32_32x32x16_bf16 v[144:159], a[228:231], v[52:55], v[144:159]
  ds_read_b64_tr_b16 a[252:253], v13 offset:15360
  ds_read_b64_tr_b16 a[254:255], v13 offset:15616
  s_mul_i32 s73, s3, 57344
  s_add_u32 s40, s40, s73
  s_waitcnt lgkmcnt(8)
  v_mfma_f32_32x32x16_bf16 v[144:159], a[232:235], v[56:59], v[144:159]
  ds_read_b64_tr_b16 a[224:225], v13 offset:16384
  ds_read_b64_tr_b16 a[226:227], v13 offset:16640
  s_lshl_b32 s41, s3, 12
  s_lshr_b32 s70, s3, 1
  s_add_u32 m0, s82, 24576
  s_add_u32 s72, s76, s53
  buffer_load_dwordx4 v9, s[12:15], s72 offen offset:0 lds
  v_mfma_f32_32x32x16_bf16 v[144:159], a[236:239], v[60:63], v[144:159]
  ds_read_b64_tr_b16 a[228:229], v13 offset:17408
  ds_read_b64_tr_b16 a[230:231], v13 offset:17664
  s_lshl_b32 s70, s70, 2
  s_andn2_b32 s71, 1, s3
  s_waitcnt lgkmcnt(8)
  v_mfma_f32_32x32x16_bf16 v[144:159], a[240:243], v[64:67], v[144:159]
  ds_read_b64_tr_b16 a[232:233], v13 offset:18432
  ds_read_b64_tr_b16 a[234:235], v13 offset:18688
  s_add_u32 s70, s70, s71
  s_lshl_b32 s71, s60, 1
  v_mfma_f32_32x32x16_bf16 v[144:159], a[244:247], v[68:71], v[144:159]
  ds_read_b64_tr_b16 a[236:237], v13 offset:19456
  ds_read_b64_tr_b16 a[238:239], v13 offset:19712
  s_add_u32 s44, s70, s71
  s_xor_b32 s45, s44, 2
  s_waitcnt lgkmcnt(8)
  v_mfma_f32_32x32x16_bf16 v[144:159], a[248:251], v[72:75], v[144:159]
  ds_read_b64_tr_b16 a[240:241], v13 offset:20480
  ds_read_b64_tr_b16 a[242:243], v13 offset:20736
  s_lshl_b32 s73, s61, 7
  s_mul_i32 s42, s44, 28672
  v_mfma_f32_32x32x16_bf16 v[144:159], a[252:255], v[76:79], v[144:159]
  ds_read_b64_tr_b16 a[244:245], v13 offset:21504
  ds_read_b64_tr_b16 a[246:247], v13 offset:21760
  s_add_u32 s42, s42, s73
  s_mul_i32 s43, s45, 28672
  s_waitcnt lgkmcnt(8)
  v_mfma_f32_32x32x16_bf16 v[144:159], a[224:227], v[80:83], v[144:159]
  ds_read_b64_tr_b16 a[248:249], v13 offset:22528
  ds_read_b64_tr_b16 a[250:251], v13 offset:22784
  s_add_u32 m0, s82, 28672
  s_add_u32 s72, s77, s47
  buffer_load_dwordx4 v7, s[12:15], s72 offen offset:0 lds
  s_add_u32 s43, s43, s73
  v_add_u32 v128, 12288, v136
  v_mfma_f32_32x32x16_bf16 v[144:159], a[228:231], v[84:87], v[144:159]
  ds_read_b64_tr_b16 a[252:253], v13 offset:23552
  ds_read_b64_tr_b16 a[254:255], v13 offset:23808
  v_add_u32 v129, 18432, v136
  v_or_b32 v192, v192, v208
  s_waitcnt lgkmcnt(8)
  v_mfma_f32_32x32x16_bf16 v[144:159], a[232:235], v[88:91], v[144:159]
  ds_read_b64_tr_b16 a[224:225], v13 offset:24576
  ds_read_b64_tr_b16 a[226:227], v13 offset:24832
  v_or_b32 v200, v200, v216
  v_or_b32 v193, v193, v209
  v_mfma_f32_32x32x16_bf16 v[144:159], a[236:239], v[92:95], v[144:159]
  ds_read_b64_tr_b16 a[228:229], v13 offset:25600
  ds_read_b64_tr_b16 a[230:231], v13 offset:25856
  v_or_b32 v201, v201, v217
  v_or_b32 v194, v194, v210
  s_waitcnt lgkmcnt(8)
  v_mfma_f32_32x32x16_bf16 v[144:159], a[240:243], v[96:99], v[144:159]
  ds_read_b64_tr_b16 a[232:233], v13 offset:26624
  ds_read_b64_tr_b16 a[234:235], v13 offset:26880
  v_or_b32 v202, v202, v218
  v_or_b32 v195, v195, v211
  v_mfma_f32_32x32x16_bf16 v[144:159], a[244:247], v[100:103], v[144:159]
  ds_read_b64_tr_b16 a[236:237], v13 offset:27648
  ds_read_b64_tr_b16 a[238:239], v13 offset:27904
  v_or_b32 v203, v203, v219
  v_or_b32 v196, v196, v212
  s_waitcnt lgkmcnt(8)
  v_mfma_f32_32x32x16_bf16 v[144:159], a[248:251], v[104:107], v[144:159]
  s_add_u32 m0, s82, 32768
  s_add_u32 s72, s77, s48
  buffer_load_dwordx4 v7, s[12:15], s72 offen offset:0 lds
  v_or_b32 v204, v204, v220
  v_or_b32 v197, v197, v213
  v_mfma_f32_32x32x16_bf16 v[144:159], a[252:255], v[108:111], v[144:159]
  v_or_b32 v205, v205, v221
  v_or_b32 v198, v198, v214
  s_waitcnt lgkmcnt(4)
  v_mfma_f32_32x32x16_bf16 v[144:159], a[224:227], v[112:115], v[144:159]
  v_or_b32 v206, v206, v222
  v_or_b32 v199, v199, v215
  v_mfma_f32_32x32x16_bf16 v[144:159], a[228:231], v[116:119], v[144:159]
  v_or_b32 v207, v207, v223
  s_waitcnt lgkmcnt(0)
  v_mfma_f32_32x32x16_bf16 v[144:159], a[232:235], v[120:123], v[144:159]
  v_mfma_f32_32x32x16_bf16 v[144:159], a[236:239], v[124:127], v[144:159]
  s_add_u32 m0, s82, 36864
  s_add_u32 s72, s77, s49
  buffer_load_dwordx4 v7, s[12:15], s72 offen offset:0 lds
  s_nop 8
  s_nop 0
  v_cvt_pk_bf16_f32 v144, v144, v145
  v_cvt_pk_bf16_f32 v145, v146, v147
  v_cvt_pk_bf16_f32 v146, v148, v149
  v_cvt_pk_bf16_f32 v147, v150, v151
  v_cvt_pk_bf16_f32 v148, v152, v153
  v_cvt_pk_bf16_f32 v149, v154, v155
  v_cvt_pk_bf16_f32 v150, v156, v157
  v_cvt_pk_bf16_f32 v151, v158, v159
  v_mfma_f32_32x32x16_bf16 v[176:191], v[192:195], v[144:147], 0
  s_nop 0
  v_mfma_f32_32x32x16_bf16 v[176:191], v[196:199], v[148:151], v[176:191]
  s_waitcnt vmcnt(6)
  s_barrier
  s_nop 0
  ds_read_b64_tr_b16 a[224:225], v11 offset:0
  ds_read_b64_tr_b16 a[226:227], v11 offset:256
  ds_read_b64_tr_b16 a[228:229], v11 offset:1024
  ds_read_b64_tr_b16 a[230:231], v11 offset:1280
  ds_read_b64_tr_b16 a[232:233], v11 offset:2048
  ds_read_b64_tr_b16 a[234:235], v11 offset:2304
  ds_read_b64_tr_b16 a[236:237], v11 offset:3072
  ds_read_b64_tr_b16 a[238:239], v11 offset:3328
  ds_read_b64_tr_b16 a[240:241], v11 offset:4096
  ds_read_b64_tr_b16 a[242:243], v11 offset:4352
  ds_read_b64_tr_b16 a[244:245], v11 offset:5120
  ds_read_b64_tr_b16 a[246:247], v11 offset:5376
  v_max3_f32 v246, v176, v177, v178
  v_max3_f32 v247, -v176, -v177, -v178
  v_max3_f32 v246, v246, v179, v180
  v_max3_f32 v247, v247, -v179, -v180
  v_max3_f32 v246, v246, v181, v182
  v_max3_f32 v247, v247, -v181, -v182
  v_max3_f32 v246, v246, v183, v184
  v_max3_f32 v247, v247, -v183, -v184
  v_max3_f32 v246, v246, v185, v186
  v_max3_f32 v247, v247, -v185, -v186
  v_max3_f32 v246, v246, v187, v188
  v_max3_f32 v247, v247, -v187, -v188
  v_max_f32 v246, v246, v189
  v_max_f32 v247, v247, -v189
  s_nop 1
  v_permlane32_swap_b32 v246, v247
  v_max_f32 v246, v246, v247
  v_mul_f32 v246, v253, v246
  v_mov_b32 v247, v246
  s_nop 1
  v_permlane32_swap_b32 v246, v247
  v_pk_fma_f32 v[232:233], v[176:177], v[252:253], v[246:247] op_sel_hi:[1,0,0]
  v_pk_fma_f32 v[176:177], v[176:177], v[252:253], v[246:247] op_sel:[0,1,1] op_sel_hi:[1,1,1]
  v_pk_fma_f32 v[234:235], v[178:179], v[252:253], v[246:247] op_sel_hi:[1,0,0]
  v_pk_fma_f32 v[178:179], v[178:179], v[252:253], v[246:247] op_sel:[0,1,1] op_sel_hi:[1,1,1]
  v_pk_fma_f32 v[236:237], v[180:181], v[252:253], v[246:247] op_sel_hi:[1,0,0]
  v_pk_fma_f32 v[180:181], v[180:181], v[252:253], v[246:247] op_sel:[0,1,1] op_sel_hi:[1,1,1]
  v_pk_fma_f32 v[238:239], v[182:183], v[252:253], v[246:247] op_sel_hi:[1,0,0]
  v_pk_fma_f32 v[182:183], v[182:183], v[252:253], v[246:247] op_sel:[0,1,1] op_sel_hi:[1,1,1]
  v_pk_fma_f32 v[240:241], v[184:185], v[252:253], v[246:247] op_sel_hi:[1,0,0]
  v_pk_fma_f32 v[184:185], v[184:185], v[252:253], v[246:247] op_sel:[0,1,1] op_sel_hi:[1,1,1]
  v_pk_fma_f32 v[242:243], v[186:187], v[252:253], v[246:247] op_sel_hi:[1,0,0]
  v_pk_fma_f32 v[186:187], v[186:187], v[252:253], v[246:247] op_sel:[0,1,1] op_sel_hi:[1,1,1]
  v_pk_fma_f32 v[244:245], v[188:189], v[252:253], v[246:247] op_sel_hi:[1,0,0]
  v_pk_fma_f32 v[188:189], v[188:189], v[252:253], v[246:247] op_sel:[0,1,1] op_sel_hi:[1,1,1]
  s_waitcnt lgkmcnt(8)
  v_mfma_f32_32x32x16_bf16 v[160:175], a[224:227], v[16:19], 0
  ds_read_b64_tr_b16 a[248:249], v11 offset:6144
  ds_read_b64_tr_b16 a[250:251], v11 offset:6400
  v_exp_f32 v232, v232
  s_add_u32 m0, s82, 40960
  s_add_u32 s72, s77, s50
  buffer_load_dwordx4 v7, s[12:15], s72 offen offset:0 lds
  v_exp_f32 v176, v176
  v_exp_f32 v233, v233
  v_mfma_f32_32x32x16_bf16 v[160:175], a[228:231], v[20:23], v[160:175]
  ds_read_b64_tr_b16 a[252:253], v11 offset:7168
  ds_read_b64_tr_b16 a[254:255], v11 offset:7424
  v_exp_f32 v177, v177
  v_exp_f32 v234, v234
  v_exp_f32 v178, v178
  s_waitcnt lgkmcnt(8)
  v_mfma_f32_32x32x16_bf16 v[160:175], a[232:235], v[24:27], v[160:175]
  ds_read_b64_tr_b16 a[224:225], v11 offset:8192
  ds_read_b64_tr_b16 a[226:227], v11 offset:8448
  v_add_f32 v248, v232, v233
  v_add_f32 v249, v176, v177
  v_exp_f32 v235, v235
  s_add_u32 m0, s82, 45056
  s_add_u32 s72, s77, s51
  buffer_load_dwordx4 v7, s[12:15], s72 offen offset:0 lds
  v_exp_f32 v179, v179
  v_mfma_f32_32x32x16_bf16 v[160:175], a[236:239], v[28:31], v[160:175]
  ds_read_b64_tr_b16 a[228:229], v11 offset:9216
  ds_read_b64_tr_b16 a[230:231], v11 offset:9472
  v_add_f32 v248, v248, v234
  v_add_f32 v249, v249, v178
  v_exp_f32 v236, v236
  v_exp_f32 v180, v180
  s_waitcnt lgkmcnt(8)
  v_mfma_f32_32x32x16_bf16 v[160:175], a[240:243], v[32:35], v[160:175]
  ds_read_b64_tr_b16 a[232:233], v11 offset:10240
  ds_read_b64_tr_b16 a[234:235], v11 offset:10496
  v_add_f32 v248, v248, v235
  v_add_f32 v249, v249, v179
  v_exp_f32 v237, v237
  v_exp_f32 v181, v181
  v_mfma_f32_32x32x16_bf16 v[160:175], a[244:247], v[36:39], v[160:175]
  ds_read_b64_tr_b16 a[236:237], v11 offset:11264
  ds_read_b64_tr_b16 a[238:239], v11 offset:11520
  s_add_u32 m0, s82, 49152
  s_add_u32 s72, s77, s52
  buffer_load_dwordx4 v7, s[12:15], s72 offen offset:0 lds
  v_add_f32 v248, v248, v236
  v_add_f32 v249, v249, v180
  v_exp_f32 v238, v238
  s_waitcnt lgkmcnt(8)
  v_mfma_f32_32x32x16_bf16 v[160:175], a[248:251], v[40:43], v[160:175]
  ds_read_b64_tr_b16 a[240:241], v11 offset:12288
  ds_read_b64_tr_b16 a[242:243], v11 offset:12544
  v_exp_f32 v182, v182
  v_add_f32 v248, v248, v237
  v_add_f32 v249, v249, v181
  v_exp_f32 v239, v239
  v_mfma_f32_32x32x16_bf16 v[160:175], a[252:255], v[44:47], v[160:175]
  ds_read_b64_tr_b16 a[244:245], v11 offset:13312
  ds_read_b64_tr_b16 a[246:247], v11 offset:13568
  v_exp_f32 v183, v183
  v_add_f32 v248, v248, v238
  s_add_u32 m0, s82, 53248
  s_add_u32 s72, s77, s53
  buffer_load_dwordx4 v7, s[12:15], s72 offen offset:0 lds
  v_add_f32 v249, v249, v182
  v_exp_f32 v240, v240
  s_waitcnt lgkmcnt(8)
  v_mfma_f32_32x32x16_bf16 v[160:175], a[224:227], v[48:51], v[160:175]
  ds_read_b64_tr_b16 a[248:249], v11 offset:14336
  ds_read_b64_tr_b16 a[250:251], v11 offset:14592
  v_exp_f32 v184, v184
  v_add_f32 v248, v248, v239
  v_add_f32 v249, v249, v183
  v_exp_f32 v241, v241
  v_mfma_f32_32x32x16_bf16 v[160:175], a[228:231], v[52:55], v[160:175]
  ds_read_b64_tr_b16 a[252:253], v11 offset:15360
  ds_read_b64_tr_b16 a[254:255], v11 offset:15616
  v_exp_f32 v185, v185
  v_add_f32 v248, v248, v240
  v_add_f32 v249, v249, v184
  v_exp_f32 v242, v242
  s_waitcnt vmcnt(7)
  s_barrier
  s_waitcnt lgkmcnt(8)
  v_mfma_f32_32x32x16_bf16 v[160:175], a[232:235], v[56:59], v[160:175]
  ds_read_b64_tr_b16 a[224:225], v11 offset:16384
  ds_read_b64_tr_b16 a[226:227], v11 offset:16640
  v_exp_f32 v186, v186
  v_add_f32 v248, v248, v241
  v_add_f32 v249, v249, v185
  v_mfma_f32_32x32x16_bf16 v[160:175], a[236:239], v[60:63], v[160:175]
  ds_read_b64_tr_b16 a[228:229], v11 offset:17408
  ds_read_b64_tr_b16 a[230:231], v11 offset:17664
  v_exp_f32 v243, v243
  v_exp_f32 v187, v187
  s_mul_i32 s72, s2, 6656
  s_mul_i32 s56, s3, 1664
  s_add_u32 s72, s72, s56
  s_mov_b64 exec, 0x1fff
  buffer_load_dword v255, v6, s[24:27], s72 offen
  buffer_load_dword v254, v6, s[28:31], s72 offen
  s_mov_b64 exec, -1
  v_add_f32 v248, v248, v242
  v_add_f32 v249, v249, v186
  s_waitcnt lgkmcnt(8)
  v_mfma_f32_32x32x16_bf16 v[160:175], a[240:243], v[64:67], v[160:175]
  ds_read_b64_tr_b16 a[232:233], v11 offset:18432
  ds_read_b64_tr_b16 a[234:235], v11 offset:18688
  v_exp_f32 v244, v244
  v_exp_f32 v188, v188
  v_add_f32 v248, v248, v243
  v_mfma_f32_32x32x16_bf16 v[160:175], a[244:247], v[68:71], v[160:175]
  ds_read_b64_tr_b16 a[236:237], v11 offset:19456
  ds_read_b64_tr_b16 a[238:239], v11 offset:19712
  v_add_f32 v249, v249, v187
  v_exp_f32 v245, v245
  v_exp_f32 v189, v189
  v_add_f32 v248, v248, v244
  s_waitcnt lgkmcnt(8)
  v_mfma_f32_32x32x16_bf16 v[160:175], a[248:251], v[72:75], v[160:175]
  ds_read_b64_tr_b16 a[240:241], v11 offset:20480
  ds_read_b64_tr_b16 a[242:243], v11 offset:20736
  v_add_f32 v249, v249, v188
  v_add_f32 v246, v248, v245
  v_add_f32 v247, v249, v189
  s_nop 1
  v_permlane32_swap_b32 v246, v247
  v_add_f32 v246, v246, v247
  v_mfma_f32_32x32x16_bf16 v[160:175], a[252:255], v[76:79], v[160:175]
  ds_read_b64_tr_b16 a[244:245], v11 offset:21504
  ds_read_b64_tr_b16 a[246:247], v11 offset:21760
  v_rcp_f32 v246, v246
  s_nop 0
  v_mov_b32 v247, v246
  s_nop 1
  v_permlane32_swap_b32 v246, v247
  s_waitcnt lgkmcnt(8)
  v_mfma_f32_32x32x16_bf16 v[160:175], a[224:227], v[80:83], v[160:175]
  ds_read_b64_tr_b16 a[248:249], v11 offset:22528
  ds_read_b64_tr_b16 a[250:251], v11 offset:22784
  v_mul_f32 v232, v232, v246
  v_mul_f32 v176, v176, v247
  v_mul_f32 v233, v233, v246
  v_mul_f32 v177, v177, v247
  v_mul_f32 v234, v234, v246
  v_mfma_f32_32x32x16_bf16 v[160:175], a[228:231], v[84:87], v[160:175]
  ds_read_b64_tr_b16 a[252:253], v11 offset:23552
  ds_read_b64_tr_b16 a[254:255], v11 offset:23808
  v_mul_f32 v178, v178, v247
  v_mul_f32 v235, v235, v246
  v_mul_f32 v179, v179, v247
  v_mul_f32 v236, v236, v246
  v_mul_f32 v180, v180, v247
  s_waitcnt lgkmcnt(8)
  v_mfma_f32_32x32x16_bf16 v[160:175], a[232:235], v[88:91], v[160:175]
  ds_read_b64_tr_b16 a[224:225], v11 offset:24576
  ds_read_b64_tr_b16 a[226:227], v11 offset:24832
  v_mul_f32 v237, v237, v246
  v_mul_f32 v181, v181, v247
  v_mul_f32 v238, v238, v246
  v_mul_f32 v182, v182, v247
  v_mul_f32 v239, v239, v246
  v_mul_f32 v183, v183, v247
  v_mfma_f32_32x32x16_bf16 v[160:175], a[236:239], v[92:95], v[160:175]
  ds_read_b64_tr_b16 a[228:229], v11 offset:25600
  ds_read_b64_tr_b16 a[230:231], v11 offset:25856
  v_mul_f32 v240, v240, v246
  v_mul_f32 v184, v184, v247
  v_mul_f32 v241, v241, v246
  v_mul_f32 v185, v185, v247
  v_mul_f32 v242, v242, v246
  s_waitcnt lgkmcnt(8)
  v_mfma_f32_32x32x16_bf16 v[160:175], a[240:243], v[96:99], v[160:175]
  ds_read_b64_tr_b16 a[232:233], v11 offset:26624
  ds_read_b64_tr_b16 a[234:235], v11 offset:26880
  v_mul_f32 v186, v186, v247
  v_mul_f32 v243, v243, v246
  v_mul_f32 v187, v187, v247
  v_mul_f32 v244, v244, v246
  v_mul_f32 v188, v188, v247
  v_mfma_f32_32x32x16_bf16 v[160:175], a[244:247], v[100:103], v[160:175]
  ds_read_b64_tr_b16 a[236:237], v11 offset:27648
  ds_read_b64_tr_b16 a[238:239], v11 offset:27904
  v_mul_f32 v245, v245, v246
  v_mul_f32 v189, v189, v247
  v_cvt_pk_bf16_f32 v208, v232, v233
  v_cvt_pk_bf16_f32 v209, v234, v235
  v_cvt_pk_bf16_f32 v210, v236, v237
  s_waitcnt lgkmcnt(8)
  v_mfma_f32_32x32x16_bf16 v[160:175], a[248:251], v[104:107], v[160:175]
  v_cvt_pk_bf16_f32 v211, v238, v239
  v_cvt_pk_bf16_f32 v212, v240, v241
  v_cvt_pk_bf16_f32 v213, v242, v243
  v_cvt_pk_bf16_f32 v214, v244, v245
  v_cvt_pk_bf16_f32 v215, v176, v177
  v_mfma_f32_32x32x16_bf16 v[160:175], a[252:255], v[108:111], v[160:175]
  v_cvt_pk_bf16_f32 v216, v178, v179
  v_cvt_pk_bf16_f32 v217, v180, v181
  v_cvt_pk_bf16_f32 v218, v182, v183
  v_cvt_pk_bf16_f32 v219, v184, v185
  v_cvt_pk_bf16_f32 v220, v186, v187
  s_waitcnt lgkmcnt(4)
  v_mfma_f32_32x32x16_bf16 v[160:175], a[224:227], v[112:115], v[160:175]
  v_cvt_pk_bf16_f32 v221, v188, v189
  ds_write_b128 v131, v[208:211] offset:57344
  v_mfma_f32_32x32x16_bf16 v[160:175], a[228:231], v[116:119], v[160:175]
  ds_write_b128 v131, v[212:215] offset:57360
  s_waitcnt lgkmcnt(2)
  v_mfma_f32_32x32x16_bf16 v[160:175], a[232:235], v[120:123], v[160:175]
  ds_write_b128 v131, v[216:219] offset:57376
  v_mfma_f32_32x32x16_bf16 v[160:175], a[236:239], v[124:127], v[160:175]
  ds_write_b64 v131, v[220:221] offset:57392
  s_nop 10
  s_nop 0
  v_pk_mul_f32 v[160:161], v[160:161], v[250:251] op_sel:[0,1] op_sel_hi:[1,1]
  v_pk_mul_f32 v[162:163], v[162:163], v[250:251] op_sel:[0,1] op_sel_hi:[1,1]
  v_pk_mul_f32 v[164:165], v[164:165], v[250:251] op_sel:[0,1] op_sel_hi:[1,1]
  v_pk_mul_f32 v[166:167], v[166:167], v[250:251] op_sel:[0,1] op_sel_hi:[1,1]
  v_pk_mul_f32 v[168:169], v[168:169], v[250:251] op_sel:[0,1] op_sel_hi:[1,1]
  v_pk_mul_f32 v[170:171], v[170:171], v[250:251] op_sel:[0,1] op_sel_hi:[1,1]
  v_pk_mul_f32 v[172:173], v[172:173], v[250:251] op_sel:[0,1] op_sel_hi:[1,1]
  v_pk_mul_f32 v[174:175], v[174:175], v[250:251] op_sel:[0,1] op_sel_hi:[1,1]
  v_cndmask_b32 v172, v172, 1.0, s[64:65]
  v_cvt_pk_bf16_f32 v224, v160, v161
  v_cvt_pk_bf16_f32 v225, v162, v163
  v_cvt_pk_bf16_f32 v226, v164, v165
  v_cvt_pk_bf16_f32 v227, v166, v167
  v_cvt_pk_bf16_f32 v228, v168, v169
  v_cvt_pk_bf16_f32 v229, v170, v171
  v_cvt_pk_bf16_f32 v230, v172, v173
  v_cvt_pk_bf16_f32 v231, v174, v175
  ds_write_b128 v131, v[224:227] offset:57408
  ds_write_b128 v131, v[228:231] offset:57424
  s_waitcnt vmcnt(5)
  s_waitcnt lgkmcnt(0)
  s_barrier
  s_nop 0
  ds_read_b64_tr_b16 v[144:145], v132 offset:0
  ds_read_b64_tr_b16 v[146:147], v132 offset:832
  ds_read_b64_tr_b16 v[208:209], v133 offset:64
  ds_read_b64_tr_b16 v[210:211], v133 offset:896
  ds_read_b64_tr_b16 v[212:213], v133 offset:80
  ds_read_b64_tr_b16 v[214:215], v133 offset:912
  ds_read_b64_tr_b16 v[148:149], v132 offset:6656
  ds_read_b64_tr_b16 v[150:151], v132 offset:7488
  ds_read_b64_tr_b16 v[216:217], v133 offset:6720
  ds_read_b64_tr_b16 v[218:219], v133 offset:7552
  ds_read_b64_tr_b16 v[220:221], v133 offset:6736
  ds_read_b64_tr_b16 v[222:223], v133 offset:7568
  ds_read_b64_tr_b16 v[152:153], v132 offset:13312
  ds_read_b64_tr_b16 v[154:155], v132 offset:14144
  ds_read_b64_tr_b16 v[224:225], v133 offset:13376
  ds_read_b64_tr_b16 v[226:227], v133 offset:14208
  ds_read_b64_tr_b16 v[228:229], v133 offset:13392
  ds_read_b64_tr_b16 v[230:231], v133 offset:14224
  ds_read_b64_tr_b16 v[156:157], v132 offset:19968
  ds_read_b64_tr_b16 v[158:159], v132 offset:20800
  ds_read_b64_tr_b16 v[232:233], v133 offset:20032
  ds_read_b64_tr_b16 v[234:235], v133 offset:20864
  ds_read_b64_tr_b16 v[236:237], v133 offset:20048
  ds_read_b64_tr_b16 v[238:239], v133 offset:20880
  s_waitcnt lgkmcnt(15)
  v_mfma_f32_16x16x32_bf16 v[176:179], v[144:147], v[208:211], 0
  v_mfma_f32_16x16x32_bf16 v[180:183], v[144:147], v[212:215], 0
  s_waitcnt lgkmcnt(14)
  v_mfma_f32_16x16x32_bf16 v[176:179], v[148:151], v[216:219], v[176:179]
  s_waitcnt lgkmcnt(12)
  v_mfma_f32_16x16x32_bf16 v[180:183], v[148:151], v[220:223], v[180:183]
  s_waitcnt lgkmcnt(8)
  v_mfma_f32_16x16x32_bf16 v[176:179], v[152:155], v[224:227], v[176:179]
  s_waitcnt lgkmcnt(6)
  v_mfma_f32_16x16x32_bf16 v[180:183], v[152:155], v[228:231], v[180:183]
  s_waitcnt lgkmcnt(2)
  v_mfma_f32_16x16x32_bf16 v[176:179], v[156:159], v[232:235], v[176:179]
  s_waitcnt lgkmcnt(0)
  v_mfma_f32_16x16x32_bf16 v[180:183], v[156:159], v[236:239], v[180:183]
  s_nop 0
  ds_read_b64_tr_b16 a[224:225], v11 offset:28672
  ds_read_b64_tr_b16 a[226:227], v11 offset:28928
  ds_read_b64_tr_b16 a[228:229], v11 offset:29696
  ds_read_b64_tr_b16 a[230:231], v11 offset:29952
  ds_read_b64_tr_b16 a[232:233], v11 offset:30720
  ds_read_b64_tr_b16 a[234:235], v11 offset:30976
  ds_read_b64_tr_b16 a[236:237], v11 offset:31744
  ds_read_b64_tr_b16 a[238:239], v11 offset:32000
  v_cvt_pk_bf16_f32 v184, v176, v177
  v_cvt_pk_bf16_f32 v185, v178, v179
  v_cvt_pk_bf16_f32 v186, v180, v181
  v_cvt_pk_bf16_f32 v187, v182, v183
  buffer_store_dwordx4 v[184:187], v2, s[36:39], s83 offen sc1
  v_xor_b32 v10, v184, v5
  buffer_store_short v10, v0, s[36:39], s84 offen sc1
  ds_read_b64_tr_b16 a[240:241], v11 offset:32768
  ds_read_b64_tr_b16 a[242:243], v11 offset:33024
  ds_read_b64_tr_b16 a[244:245], v11 offset:33792
  ds_read_b64_tr_b16 a[246:247], v11 offset:34048
  s_waitcnt lgkmcnt(8)
  v_mfma_f32_32x32x16_bf16 v[160:175], a[224:227], v[16:19], 0
  ds_read_b64_tr_b16 a[248:249], v11 offset:34816
  ds_read_b64_tr_b16 a[250:251], v11 offset:35072
  s_add_u32 m0, s75, 86016
  s_add_u32 s57, s63, 0
  buffer_load_dwordx4 v136, s[20:23], s57 offen offset:0 lds
  v_mfma_f32_32x32x16_bf16 v[160:175], a[228:231], v[20:23], v[160:175]
  ds_read_b64_tr_b16 a[252:253], v11 offset:35840
  ds_read_b64_tr_b16 a[254:255], v11 offset:36096
  s_waitcnt lgkmcnt(8)
  v_mfma_f32_32x32x16_bf16 v[160:175], a[232:235], v[24:27], v[160:175]
  ds_read_b64_tr_b16 a[224:225], v11 offset:36864
  ds_read_b64_tr_b16 a[226:227], v11 offset:37120
  s_cmp_eq_u32 s3, 3
  s_cselect_b64 vcc, s[64:65], 0
  v_mov_b32 v143, 0x10000000
  v_add_u32 v133, s82, v2
  v_cndmask_b32 v142, v5, 0, vcc
  v_cndmask_b32 v134, v134, v143, vcc
  v_cndmask_b32 v135, v135, v143, vcc
  buffer_load_dwordx4 v137, s[20:23], s57 offen offset:1024 lds
  v_mfma_f32_32x32x16_bf16 v[160:175], a[236:239], v[28:31], v[160:175]
  ds_read_b64_tr_b16 a[228:229], v11 offset:37888
  ds_read_b64_tr_b16 a[230:231], v11 offset:38144
  s_add_u32 m0, s75, 94208
  s_add_u32 s57, s63, 57344
  buffer_load_dwordx4 v136, s[20:23], s57 offen offset:0 lds
  s_waitcnt lgkmcnt(8)
  v_mfma_f32_32x32x16_bf16 v[160:175], a[240:243], v[32:35], v[160:175]
  ds_read_b64_tr_b16 a[232:233], v11 offset:38912
  ds_read_b64_tr_b16 a[234:235], v11 offset:39168
  s_lshr_b32 s50, s4, 2
  s_add_u32 s50, s50, 0
  v_mfma_f32_32x32x16_bf16 v[160:175], a[244:247], v[36:39], v[160:175]
  ds_read_b64_tr_b16 a[236:237], v11 offset:39936
  ds_read_b64_tr_b16 a[238:239], v11 offset:40192
  s_and_b32 s50, s50, 3
  s_waitcnt lgkmcnt(8)
  v_mfma_f32_32x32x16_bf16 v[160:175], a[248:251], v[40:43], v[160:175]
  ds_read_b64_tr_b16 a[240:241], v11 offset:40960
  ds_read_b64_tr_b16 a[242:243], v11 offset:41216
  buffer_load_dwordx4 v137, s[20:23], s57 offen offset:1024 lds
  s_mul_i32 s50, s50, 18432
  v_mfma_f32_32x32x16_bf16 v[160:175], a[252:255], v[44:47], v[160:175]
  ds_read_b64_tr_b16 a[244:245], v11 offset:41984
  ds_read_b64_tr_b16 a[246:247], v11 offset:42240
  s_add_u32 m0, s75, 102400
  s_add_u32 s57, s63, 114688
  buffer_load_dwordx4 v136, s[20:23], s57 offen offset:0 lds
  s_add_u32 s50, s50, s59
  s_waitcnt lgkmcnt(8)
  v_mfma_f32_32x32x16_bf16 v[160:175], a[224:227], v[48:51], v[160:175]
  ds_read_b64_tr_b16 a[248:249], v11 offset:43008
  ds_read_b64_tr_b16 a[250:251], v11 offset:43264
  s_lshr_b32 s51, s4, 2
  s_cmp_ge_u32 s74, 14
  s_cselect_b32 s26, 0, s26
  s_add_u32 s51, s51, 1
  v_mfma_f32_32x32x16_bf16 v[160:175], a[228:231], v[52:55], v[160:175]
  ds_read_b64_tr_b16 a[252:253], v11 offset:44032
  ds_read_b64_tr_b16 a[254:255], v11 offset:44288
  s_and_b32 s51, s51, 3
  buffer_load_dwordx4 v137, s[20:23], s57 offen offset:1024 lds
  s_waitcnt vmcnt(10)
  s_barrier
  s_waitcnt lgkmcnt(8)
  v_mfma_f32_32x32x16_bf16 v[160:175], a[232:235], v[56:59], v[160:175]
  ds_read_b64_tr_b16 a[224:225], v11 offset:45056
  ds_read_b64_tr_b16 a[226:227], v11 offset:45312
  v_lshrrev_b32 v10, 4, v1
  s_mul_i32 s51, s51, 18432
  s_add_u32 m0, s75, 110592
  s_add_u32 s57, s63, 172032
  buffer_load_dwordx4 v136, s[20:23], s57 offen offset:0 lds
  v_mul_u32_u24 v12, 3584, v10
  v_mfma_f32_32x32x16_bf16 v[160:175], a[236:239], v[60:63], v[160:175]
  ds_read_b64_tr_b16 a[228:229], v11 offset:46080
  ds_read_b64_tr_b16 a[230:231], v11 offset:46336
  s_add_u32 s51, s51, s59
  v_lshlrev_b32 v10, 2, v10
  s_waitcnt lgkmcnt(8)
  v_mfma_f32_32x32x16_bf16 v[160:175], a[240:243], v[64:67], v[160:175]
  ds_read_b64_tr_b16 a[232:233], v11 offset:47104
  ds_read_b64_tr_b16 a[234:235], v11 offset:47360
  s_lshr_b32 s52, s4, 2
  v_and_b32 v13, 15, v1
  s_add_u32 s52, s52, 2
  v_mfma_f32_32x32x16_bf16 v[160:175], a[244:247], v[68:71], v[160:175]
  ds_read_b64_tr_b16 a[236:237], v11 offset:48128
  ds_read_b64_tr_b16 a[238:239], v11 offset:48384
  buffer_load_dwordx4 v137, s[20:23], s57 offen offset:1024 lds
  v_xor_b32 v10, v10, v13
  s_and_b32 s52, s52, 3
  s_waitcnt lgkmcnt(8)
  v_mfma_f32_32x32x16_bf16 v[160:175], a[248:251], v[72:75], v[160:175]
  ds_read_b64_tr_b16 a[240:241], v11 offset:49152
  ds_read_b64_tr_b16 a[242:243], v11 offset:49408
  s_add_u32 m0, s75, 118784
  s_add_u32 s57, s63, 229376
  buffer_load_dwordx4 v136, s[20:23], s57 offen offset:0 lds
  s_mul_i32 s52, s52, 18432
  v_lshl_add_u32 v12, v10, 4, v12
  v_mfma_f32_32x32x16_bf16 v[160:175], a[252:255], v[76:79], v[160:175]
  ds_read_b64_tr_b16 a[244:245], v11 offset:50176
  ds_read_b64_tr_b16 a[246:247], v11 offset:50432
  s_add_u32 s52, s52, s59
  v_add_u32 v13, 13312, v12
  s_waitcnt lgkmcnt(8)
  v_mfma_f32_32x32x16_bf16 v[160:175], a[224:227], v[80:83], v[160:175]
  ds_read_b64_tr_b16 a[248:249], v11 offset:51200
  ds_read_b64_tr_b16 a[250:251], v11 offset:51456
  s_lshr_b32 s53, s4, 2
  v_add_u32 v14, 26624, v12
  buffer_load_dwordx4 v137, s[20:23], s57 offen offset:1024 lds
  s_add_u32 s53, s53, 3
  v_mfma_f32_32x32x16_bf16 v[160:175], a[228:231], v[84:87], v[160:175]
  ds_read_b64_tr_b16 a[252:253], v11 offset:52224
  ds_read_b64_tr_b16 a[254:255], v11 offset:52480
  v_add_u32 v15, 39936, v12
  s_add_u32 m0, s75, 126976
  s_add_u32 s57, s63, 286720
  buffer_load_dwordx4 v136, s[20:23], s57 offen offset:0 lds
  s_and_b32 s53, s53, 3
  s_waitcnt lgkmcnt(8)
  v_mfma_f32_32x32x16_bf16 v[160:175], a[232:235], v[88:91], v[160:175]
  ds_read_b64_tr_b16 a[224:225], v11 offset:53248
  ds_read_b64_tr_b16 a[226:227], v11 offset:53504
  s_mul_i32 s53, s53, 18432
  v_mfma_f32_32x32x16_bf16 v[160:175], a[236:239], v[92:95], v[160:175]
  ds_read_b64_tr_b16 a[228:229], v11 offset:54272
  ds_read_b64_tr_b16 a[230:231], v11 offset:54528
  s_add_u32 s53, s53, s59
  s_waitcnt lgkmcnt(8)
  v_mfma_f32_32x32x16_bf16 v[160:175], a[240:243], v[96:99], v[160:175]
  ds_read_b64_tr_b16 a[232:233], v11 offset:55296
  ds_read_b64_tr_b16 a[234:235], v11 offset:55552
  buffer_load_dwordx4 v137, s[20:23], s57 offen offset:1024 lds
  v_mfma_f32_32x32x16_bf16 v[160:175], a[244:247], v[100:103], v[160:175]
  ds_read_b64_tr_b16 a[236:237], v11 offset:56320
  ds_read_b64_tr_b16 a[238:239], v11 offset:56576
  s_add_u32 m0, s75, 135168
  s_add_u32 s57, s63, 344064
  buffer_load_dwordx4 v136, s[20:23], s57 offen offset:0 lds
  s_waitcnt lgkmcnt(8)
  v_mfma_f32_32x32x16_bf16 v[160:175], a[248:251], v[104:107], v[160:175]
  v_mfma_f32_32x32x16_bf16 v[160:175], a[252:255], v[108:111], v[160:175]
  buffer_load_dwordx4 v137, s[20:23], s57 offen offset:1024 lds
  s_waitcnt lgkmcnt(4)
  v_mfma_f32_32x32x16_bf16 v[160:175], a[224:227], v[112:115], v[160:175]
  s_add_u32 m0, s75, 147456
  s_add_u32 s57, s86, 0
  buffer_load_dwordx4 v138, s[8:11], s57 offen offset:0 lds
  v_mfma_f32_32x32x16_bf16 v[160:175], a[228:231], v[116:119], v[160:175]
  s_waitcnt lgkmcnt(0)
  v_mfma_f32_32x32x16_bf16 v[160:175], a[232:235], v[120:123], v[160:175]
  v_mfma_f32_32x32x16_bf16 v[160:175], a[236:239], v[124:127], v[160:175]
  buffer_load_dwordx4 v139, s[8:11], s57 offen offset:1024 lds
  s_add_u32 s56, s50, 0
  s_nop 0
  buffer_load_dwordx4 v[16:19], v134, s[36:39], s56 offen sc1
  buffer_load_ushort v80, v135, s[36:39], s56 offen sc1
  s_add_u32 s56, s50, 4608
  buffer_load_dwordx4 v[20:23], v134, s[36:39], s56 offen sc1
  buffer_load_ushort v81, v135, s[36:39], s56 offen sc1
  s_add_u32 s56, s50, 9216
  buffer_load_dwordx4 v[24:27], v134, s[36:39], s56 offen sc1
  buffer_load_ushort v82, v135, s[36:39], s56 offen sc1
  s_add_u32 s56, s50, 13824
  buffer_load_dwordx4 v[28:31], v134, s[36:39], s56 offen sc1
  buffer_load_ushort v83, v135, s[36:39], s56 offen sc1
  v_cvt_pk_bf16_f32 v160, v160, v161
  v_cvt_pk_bf16_f32 v161, v162, v163
  v_cvt_pk_bf16_f32 v162, v164, v165
  v_cvt_pk_bf16_f32 v163, v166, v167
  v_cvt_pk_bf16_f32 v164, v168, v169
  v_cvt_pk_bf16_f32 v165, v170, v171
  v_cvt_pk_bf16_f32 v166, v172, v173
  v_cvt_pk_bf16_f32 v167, v174, v175
  v_mfma_f32_32x32x16_bf16 v[176:191], v[200:203], v[160:163], 0
  s_nop 0
  v_mfma_f32_32x32x16_bf16 v[176:191], v[204:207], v[164:167], v[176:191]
  s_barrier
  s_nop 10
  s_nop 0
  v_max3_f32 v246, v176, v177, v178
  v_max3_f32 v247, -v176, -v177, -v178
  v_max3_f32 v246, v246, v179, v180
  v_max3_f32 v247, v247, -v179, -v180
  v_max3_f32 v246, v246, v181, v182
  v_max3_f32 v247, v247, -v181, -v182
  v_max3_f32 v246, v246, v183, v184
  v_max3_f32 v247, v247, -v183, -v184
  v_max3_f32 v246, v246, v185, v186
  v_max3_f32 v247, v247, -v185, -v186
  v_max3_f32 v246, v246, v187, v188
  v_max3_f32 v247, v247, -v187, -v188
  v_max_f32 v246, v246, v189
  v_max_f32 v247, v247, -v189
  s_nop 1
  v_permlane32_swap_b32 v246, v247
  v_max_f32 v246, v246, v247
  v_mul_f32 v246, v253, v246
  v_mov_b32 v247, v246
  s_nop 1
  v_permlane32_swap_b32 v246, v247
  v_pk_fma_f32 v[232:233], v[176:177], v[252:253], v[246:247] op_sel_hi:[1,0,0]
  v_pk_fma_f32 v[176:177], v[176:177], v[252:253], v[246:247] op_sel:[0,1,1] op_sel_hi:[1,1,1]
  v_pk_fma_f32 v[234:235], v[178:179], v[252:253], v[246:247] op_sel_hi:[1,0,0]
  v_pk_fma_f32 v[178:179], v[178:179], v[252:253], v[246:247] op_sel:[0,1,1] op_sel_hi:[1,1,1]
  v_pk_fma_f32 v[236:237], v[180:181], v[252:253], v[246:247] op_sel_hi:[1,0,0]
  v_pk_fma_f32 v[180:181], v[180:181], v[252:253], v[246:247] op_sel:[0,1,1] op_sel_hi:[1,1,1]
  v_pk_fma_f32 v[238:239], v[182:183], v[252:253], v[246:247] op_sel_hi:[1,0,0]
  v_pk_fma_f32 v[182:183], v[182:183], v[252:253], v[246:247] op_sel:[0,1,1] op_sel_hi:[1,1,1]
  v_pk_fma_f32 v[240:241], v[184:185], v[252:253], v[246:247] op_sel_hi:[1,0,0]
  v_pk_fma_f32 v[184:185], v[184:185], v[252:253], v[246:247] op_sel:[0,1,1] op_sel_hi:[1,1,1]
  v_pk_fma_f32 v[242:243], v[186:187], v[252:253], v[246:247] op_sel_hi:[1,0,0]
  s_add_u32 s56, s51, 0
  buffer_load_dwordx4 v[32:35], v134, s[36:39], s56 offen sc1
  buffer_load_ushort v84, v135, s[36:39], s56 offen sc1
  v_pk_fma_f32 v[186:187], v[186:187], v[252:253], v[246:247] op_sel:[0,1,1] op_sel_hi:[1,1,1]
  v_pk_fma_f32 v[244:245], v[188:189], v[252:253], v[246:247] op_sel_hi:[1,0,0]
  v_pk_fma_f32 v[188:189], v[188:189], v[252:253], v[246:247] op_sel:[0,1,1] op_sel_hi:[1,1,1]
  v_exp_f32 v232, v232
  v_exp_f32 v233, v233
  v_exp_f32 v234, v234
  s_add_u32 s56, s51, 4608
  buffer_load_dwordx4 v[36:39], v134, s[36:39], s56 offen sc1
  buffer_load_ushort v85, v135, s[36:39], s56 offen sc1
  v_exp_f32 v235, v235
  v_exp_f32 v236, v236
  v_exp_f32 v237, v237
  v_exp_f32 v238, v238
  v_exp_f32 v239, v239
  v_exp_f32 v240, v240
  s_add_u32 s56, s51, 9216
  buffer_load_dwordx4 v[40:43], v134, s[36:39], s56 offen sc1
  buffer_load_ushort v86, v135, s[36:39], s56 offen sc1
  v_exp_f32 v241, v241
  v_exp_f32 v242, v242
  v_exp_f32 v243, v243
  v_exp_f32 v244, v244
  v_exp_f32 v245, v245
  v_exp_f32 v176, v176
  s_add_u32 s56, s51, 13824
  buffer_load_dwordx4 v[44:47], v134, s[36:39], s56 offen sc1
  buffer_load_ushort v87, v135, s[36:39], s56 offen sc1
  v_exp_f32 v177, v177
  v_exp_f32 v178, v178
  v_exp_f32 v179, v179
  v_exp_f32 v180, v180
  v_exp_f32 v181, v181
  v_exp_f32 v182, v182
  s_add_u32 s56, s52, 0
  buffer_load_dwordx4 v[48:51], v134, s[36:39], s56 offen sc1
  buffer_load_ushort v88, v135, s[36:39], s56 offen sc1
  v_exp_f32 v183, v183
  v_exp_f32 v184, v184
  v_exp_f32 v185, v185
  v_exp_f32 v186, v186
  v_exp_f32 v187, v187
  v_exp_f32 v188, v188
  s_add_u32 s56, s52, 4608
  buffer_load_dwordx4 v[52:55], v134, s[36:39], s56 offen sc1
  buffer_load_ushort v89, v135, s[36:39], s56 offen sc1
  v_exp_f32 v189, v189
  v_pk_add_f32 v[246:247], v[232:233], v[234:235]
  v_pk_add_f32 v[248:249], v[176:177], v[178:179]
  v_pk_add_f32 v[246:247], v[246:247], v[236:237]
  v_pk_add_f32 v[248:249], v[248:249], v[180:181]
  v_pk_add_f32 v[246:247], v[246:247], v[238:239]
  s_add_u32 s56, s52, 9216
  buffer_load_dwordx4 v[56:59], v134, s[36:39], s56 offen sc1
  buffer_load_ushort v90, v135, s[36:39], s56 offen sc1
  v_pk_add_f32 v[248:249], v[248:249], v[182:183]
  v_pk_add_f32 v[246:247], v[246:247], v[240:241]
  v_pk_add_f32 v[248:249], v[248:249], v[184:185]
  v_pk_add_f32 v[246:247], v[246:247], v[242:243]
  v_pk_add_f32 v[248:249], v[248:249], v[186:187]
  v_pk_add_f32 v[246:247], v[246:247], v[244:245]
  s_add_u32 s56, s52, 13824
  buffer_load_dwordx4 v[60:63], v134, s[36:39], s56 offen sc1
  buffer_load_ushort v91, v135, s[36:39], s56 offen sc1
  v_pk_add_f32 v[248:249], v[248:249], v[188:189]
  v_add_f32 v246, v246, v247
  v_add_f32 v247, v248, v249
  s_nop 1
  v_permlane32_swap_b32 v246, v247
  v_add_f32 v246, v246, v247
  v_rcp_f32 v246, v246
  s_add_u32 s56, s53, 0
  buffer_load_dwordx4 v[64:67], v134, s[36:39], s56 offen sc1
  buffer_load_ushort v92, v135, s[36:39], s56 offen sc1
  v_mov_b32 v247, v246
  s_nop 1
  v_permlane32_swap_b32 v246, v247
  v_pk_mul_f32 v[232:233], v[232:233], v[246:247] op_sel_hi:[1,0]
  v_pk_mul_f32 v[176:177], v[176:177], v[246:247] op_sel:[0,1] op_sel_hi:[1,1]
  v_pk_mul_f32 v[234:235], v[234:235], v[246:247] op_sel_hi:[1,0]
  v_pk_mul_f32 v[178:179], v[178:179], v[246:247] op_sel:[0,1] op_sel_hi:[1,1]
  s_add_u32 s56, s53, 4608
  buffer_load_dwordx4 v[68:71], v134, s[36:39], s56 offen sc1
  buffer_load_ushort v93, v135, s[36:39], s56 offen sc1
  v_pk_mul_f32 v[236:237], v[236:237], v[246:247] op_sel_hi:[1,0]
  v_pk_mul_f32 v[180:181], v[180:181], v[246:247] op_sel:[0,1] op_sel_hi:[1,1]
  v_pk_mul_f32 v[238:239], v[238:239], v[246:247] op_sel_hi:[1,0]
  v_pk_mul_f32 v[182:183], v[182:183], v[246:247] op_sel:[0,1] op_sel_hi:[1,1]
  v_pk_mul_f32 v[240:241], v[240:241], v[246:247] op_sel_hi:[1,0]
  v_pk_mul_f32 v[184:185], v[184:185], v[246:247] op_sel:[0,1] op_sel_hi:[1,1]
  s_add_u32 s56, s53, 9216
  buffer_load_dwordx4 v[72:75], v134, s[36:39], s56 offen sc1
  buffer_load_ushort v94, v135, s[36:39], s56 offen sc1
  v_pk_mul_f32 v[242:243], v[242:243], v[246:247] op_sel_hi:[1,0]
  v_pk_mul_f32 v[186:187], v[186:187], v[246:247] op_sel:[0,1] op_sel_hi:[1,1]
  v_pk_mul_f32 v[244:245], v[244:245], v[246:247] op_sel_hi:[1,0]
  v_pk_mul_f32 v[188:189], v[188:189], v[246:247] op_sel:[0,1] op_sel_hi:[1,1]
  v_cvt_pk_bf16_f32 v208, v232, v233
  v_cvt_pk_bf16_f32 v209, v234, v235
  s_add_u32 s56, s53, 13824
  buffer_load_dwordx4 v[76:79], v134, s[36:39], s56 offen sc1
  buffer_load_ushort v95, v135, s[36:39], s56 offen sc1
  v_cvt_pk_bf16_f32 v210, v236, v237
  v_cvt_pk_bf16_f32 v211, v238, v239
  v_cvt_pk_bf16_f32 v212, v240, v241
  v_cvt_pk_bf16_f32 v213, v242, v243
  v_cvt_pk_bf16_f32 v214, v244, v245
  v_cvt_pk_bf16_f32 v215, v176, v177
  v_cvt_pk_bf16_f32 v216, v178, v179
  v_cvt_pk_bf16_f32 v217, v180, v181
  v_cvt_pk_bf16_f32 v218, v182, v183
  v_cvt_pk_bf16_f32 v219, v184, v185
  v_cvt_pk_bf16_f32 v220, v186, v187
  v_cvt_pk_bf16_f32 v221, v188, v189
L_fp_go:
  s_waitcnt vmcnt(30)
  v_bitop3_b32 v10, v16, v80, v142 bitop3:0x96
  s_waitcnt vmcnt(28)
  v_bitop3_b32 v9, v20, v81, v142 bitop3:0x96
  v_or_b32 v10, v10, v9
  s_waitcnt vmcnt(26)
  v_bitop3_b32 v9, v24, v82, v142 bitop3:0x96
  v_or_b32 v10, v10, v9
  s_waitcnt vmcnt(24)
  v_bitop3_b32 v9, v28, v83, v142 bitop3:0x96
  v_or_b32 v10, v10, v9
  v_cmp_ne_u16 vcc, 0, v10
  s_cbranch_vccnz L_fp_retry
  v_mfma_f32_32x32x16_bf16 v[96:111], a[220:223], v[16:19], 0
  v_mfma_f32_32x32x16_bf16 v[96:111], a[220:223], v[20:23], v[96:111]
  s_waitcnt vmcnt(22)
  v_bitop3_b32 v10, v32, v84, v142 bitop3:0x96
  s_waitcnt vmcnt(20)
  v_bitop3_b32 v9, v36, v85, v142 bitop3:0x96
  v_or_b32 v10, v10, v9
  v_mfma_f32_32x32x16_bf16 v[96:111], a[220:223], v[24:27], v[96:111]
  s_waitcnt vmcnt(18)
  v_bitop3_b32 v9, v40, v86, v142 bitop3:0x96
  s_add_u32 m0, s41, 0
  s_add_u32 s57, s40, 0
  buffer_load_dwordx4 v12, s[24:27], s57 offen offset:0 lds
  v_or_b32 v10, v10, v9
  s_waitcnt vmcnt(17)
  v_bitop3_b32 v9, v44, v87, v142 bitop3:0x96
  v_mfma_f32_32x32x16_bf16 v[96:111], a[220:223], v[28:31], v[96:111]
  v_or_b32 v10, v10, v9
  v_cmp_ne_u16 vcc, 0, v10
  s_cbranch_vccnz L_fp_retry
  v_mfma_f32_32x32x16_bf16 v[96:111], a[220:223], v[32:35], v[96:111]
  v_mfma_f32_32x32x16_bf16 v[96:111], a[220:223], v[36:39], v[96:111]
  s_waitcnt vmcnt(15)
  v_bitop3_b32 v10, v48, v88, v142 bitop3:0x96
  s_waitcnt vmcnt(13)
  v_bitop3_b32 v9, v52, v89, v142 bitop3:0x96
  buffer_load_dwordx4 v13, s[24:27], s57 offen offset:1024 lds
  v_or_b32 v10, v10, v9
  v_mfma_f32_32x32x16_bf16 v[96:111], a[220:223], v[40:43], v[96:111]
  s_waitcnt vmcnt(12)
  v_bitop3_b32 v9, v56, v90, v142 bitop3:0x96
  v_or_b32 v10, v10, v9
  s_waitcnt vmcnt(10)
  v_bitop3_b32 v9, v60, v91, v142 bitop3:0x96
  buffer_load_dwordx4 v14, s[24:27], s57 offen offset:2048 lds
  v_mfma_f32_32x32x16_bf16 v[96:111], a[220:223], v[44:47], v[96:111]
  v_or_b32 v10, v10, v9
  v_cmp_ne_u16 vcc, 0, v10
  s_cbranch_vccnz L_fp_retry
  buffer_load_dwordx4 v15, s[24:27], s57 offen offset:3072 lds
  v_mfma_f32_32x32x16_bf16 v[96:111], a[220:223], v[48:51], v[96:111]
  v_mfma_f32_32x32x16_bf16 v[96:111], a[220:223], v[52:55], v[96:111]
  s_waitcnt vmcnt(10)
  v_bitop3_b32 v10, v64, v92, v142 bitop3:0x96
  s_add_u32 m0, s41, 16384
  s_add_u32 s57, s40, 229376
  buffer_load_dwordx4 v12, s[24:27], s57 offen offset:0 lds
  s_waitcnt vmcnt(9)
  v_bitop3_b32 v9, v68, v93, v142 bitop3:0x96
  v_or_b32 v10, v10, v9
  v_mfma_f32_32x32x16_bf16 v[96:111], a[220:223], v[56:59], v[96:111]
  s_waitcnt vmcnt(7)
  v_bitop3_b32 v9, v72, v94, v142 bitop3:0x96
  v_or_b32 v10, v10, v9
  s_waitcnt vmcnt(5)
  v_bitop3_b32 v9, v76, v95, v142 bitop3:0x96
  v_mfma_f32_32x32x16_bf16 v[96:111], a[220:223], v[60:63], v[96:111]
  v_or_b32 v10, v10, v9
  v_cmp_ne_u16 vcc, 0, v10
  s_cbranch_vccnz L_fp_retry
  v_mfma_f32_32x32x16_bf16 v[96:111], a[220:223], v[64:67], v[96:111]
  buffer_load_dwordx4 v13, s[24:27], s57 offen offset:1024 lds
  v_mfma_f32_32x32x16_bf16 v[96:111], a[220:223], v[68:71], v[96:111]
  buffer_load_dwordx4 v14, s[24:27], s57 offen offset:2048 lds
  v_mfma_f32_32x32x16_bf16 v[96:111], a[220:223], v[72:75], v[96:111]
  buffer_load_dwordx4 v15, s[24:27], s57 offen offset:3072 lds
  v_mfma_f32_32x32x16_bf16 v[96:111], a[220:223], v[76:79], v[96:111]
  v_add_u32 v9, 143360, v133
  s_nop 10
  v_cvt_pk_bf16_f32 v104, v96, v97
  v_cvt_pk_bf16_f32 v105, v98, v99
  v_cvt_pk_bf16_f32 v106, v100, v101
  v_cvt_pk_bf16_f32 v107, v102, v103
  ds_write_b128 v9, v[104:107]
  s_waitcnt lgkmcnt(0)
  s_barrier
  s_nop 0
  ds_read_b64 v[32:33], v130 offset:0
  ds_read_b64 v[34:35], v130 offset:512
  ds_read_b64 v[36:37], v130 offset:1024
  ds_read_b64 v[38:39], v130 offset:1536
  ds_read_b64 v[40:41], v130 offset:2048
  ds_read_b64 v[42:43], v130 offset:2560
  ds_read_b64 v[44:45], v130 offset:3072
  s_add_u32 m0, s41, 32768
  s_add_u32 s57, s40, 458752
  buffer_load_dwordx4 v12, s[24:27], s57 offen offset:0 lds
  s_waitcnt lgkmcnt(5)
  v_mfma_f32_32x32x16_bf16 v[48:63], v[32:35], v[208:211], 0
  s_waitcnt lgkmcnt(3)
  v_mfma_f32_32x32x16_bf16 v[48:63], v[36:39], v[212:215], v[48:63]
  buffer_load_dwordx4 v13, s[24:27], s57 offen offset:1024 lds
  s_waitcnt lgkmcnt(1)
  v_mfma_f32_32x32x16_bf16 v[48:63], v[40:43], v[216:219], v[48:63]
  s_waitcnt lgkmcnt(0)
  v_mfma_f32_32x32x8_bf16 v[48:63], v[44:45], v[220:221], v[48:63]
  s_lshl_b32 s59, s69, 15
  s_lshr_b32 s71, s3, 1
  s_lshl_b32 s71, s71, 13
  s_add_u32 s59, s59, s71
  s_and_b32 s70, s5, 8
  s_lshl_b32 s71, s70, 11
  s_add_u32 s59, s59, s71
  s_add_u32 s59, s59, 2359296
  s_xor_b32 s50, s59, 16384
  s_mul_i32 s71, s70, 3584
  v_add_u32 v142, s71, v141
  s_sub_u32 s71, 28672, s71
  v_add_u32 v143, s71, v141
  v_and_b32 v7, 31, v1
  v_mul_u32_u24 v7, 896, v7
  v_add_f32 v62, 0x358637bd, v62
  v_rcp_f32_e64 v62, v62
  v_lshl_add_u32 v7, v3, 4, v7
  v_pk_mul_f32 v[48:49], v[48:49], v[62:63] op_sel_hi:[1,0]
  v_pk_mul_f32 v[50:51], v[50:51], v[62:63] op_sel_hi:[1,0]
  v_pk_mul_f32 v[52:53], v[52:53], v[62:63] op_sel_hi:[1,0]
  v_pk_mul_f32 v[54:55], v[54:55], v[62:63] op_sel_hi:[1,0]
  v_pk_mul_f32 v[56:57], v[56:57], v[62:63] op_sel_hi:[1,0]
  v_pk_mul_f32 v[58:59], v[58:59], v[62:63] op_sel_hi:[1,0]
  v_pk_mul_f32 v[60:61], v[60:61], v[62:63] op_sel_hi:[1,0]
  v_cvt_pk_bf16_f32 v64, v48, v49
  v_cvt_pk_bf16_f32 v65, v50, v51
  v_cvt_pk_bf16_f32 v66, v52, v53
  v_cvt_pk_bf16_f32 v67, v54, v55
  buffer_store_dwordx4 v[64:67], v2, s[36:39], s85 offen sc1
  v_cvt_pk_bf16_f32 v68, v56, v57
  v_cvt_pk_bf16_f32 v69, v58, v59
  v_cvt_pk_bf16_f32 v70, v60, v61
  v_bitop3_b32 v71, v64, v5, s62 bitop3:0x28
  v_and_b32 v6, s62, v5
  buffer_store_dwordx4 v[68:71], v2, s[36:39], s85 offen offset:1024 sc1
  s_cmp_ge_u32 s74, 14
  s_cbranch_scc1 L_exit
  s_barrier
  s_add_u32 s70, s41, 147456
  v_add_u32 v132, s70, v2
  v_xor_b32 v133, 8192, v132
  v_xor_b32 v9, 64, v142
  v_xor_b32 v141, 64, v143
  ds_read_b64 v[224:225], v140
  v_xor_b32 v10, 16, v140
  ds_read_b64 v[226:227], v10
  v_xor_b32 v10, 32, v140
  ds_read_b64 v[228:229], v10
  v_xor_b32 v10, 48, v140
  ds_read_b64 v[230:231], v10
  buffer_load_dwordx4 v14, s[24:27], s57 offen offset:2048 lds
  ds_read_b64_tr_b16 a[128:129], v142 offset:0
  ds_read_b64_tr_b16 a[130:131], v142 offset:512
  ds_read_b64_tr_b16 a[132:133], v9 offset:0
  ds_read_b64_tr_b16 a[134:135], v9 offset:512
  buffer_load_dwordx4 v15, s[24:27], s57 offen offset:3072 lds
  ds_read_b64_tr_b16 a[136:137], v142 offset:1024
  ds_read_b64_tr_b16 a[138:139], v142 offset:1536
  ds_read_b64_tr_b16 a[140:141], v9 offset:1024
  ds_read_b64_tr_b16 a[142:143], v9 offset:1536
  s_add_u32 m0, s41, 49152
  s_add_u32 s57, s40, 688128
  buffer_load_dwordx4 v12, s[24:27], s57 offen offset:0 lds
  ds_read_b64_tr_b16 a[144:145], v142 offset:3584
  ds_read_b64_tr_b16 a[146:147], v142 offset:4096
  ds_read_b64_tr_b16 a[148:149], v9 offset:3584
  ds_read_b64_tr_b16 a[150:151], v9 offset:4096
  buffer_load_dwordx4 v13, s[24:27], s57 offen offset:1024 lds
  ds_read_b64_tr_b16 a[152:153], v142 offset:4608
  ds_read_b64_tr_b16 a[154:155], v142 offset:5120
  ds_read_b64_tr_b16 a[156:157], v9 offset:4608
  ds_read_b64_tr_b16 a[158:159], v9 offset:5120
  buffer_load_dwordx4 v14, s[24:27], s57 offen offset:2048 lds
  ds_read_b64_tr_b16 a[160:161], v142 offset:7168
  ds_read_b64_tr_b16 a[162:163], v142 offset:7680
  ds_read_b64_tr_b16 a[164:165], v9 offset:7168
  ds_read_b64_tr_b16 a[166:167], v9 offset:7680
  buffer_load_dwordx4 v15, s[24:27], s57 offen offset:3072 lds
  ds_read_b64_tr_b16 a[168:169], v142 offset:8192
  ds_read_b64_tr_b16 a[170:171], v142 offset:8704
  ds_read_b64_tr_b16 a[172:173], v9 offset:8192
  ds_read_b64_tr_b16 a[174:175], v9 offset:8704
  s_add_u32 m0, s41, 65536
  s_add_u32 s57, s40, 917504
  buffer_load_dwordx4 v12, s[24:27], s57 offen offset:0 lds
  ds_read_b64_tr_b16 a[176:177], v142 offset:10752
  ds_read_b64_tr_b16 a[178:179], v142 offset:11264
  ds_read_b64_tr_b16 a[180:181], v9 offset:10752
  ds_read_b64_tr_b16 a[182:183], v9 offset:11264
  buffer_load_dwordx4 v13, s[24:27], s57 offen offset:1024 lds
  ds_read_b64_tr_b16 a[184:185], v142 offset:11776
  ds_read_b64_tr_b16 a[186:187], v142 offset:12288
  ds_read_b64_tr_b16 a[188:189], v9 offset:11776
  ds_read_b64_tr_b16 a[190:191], v9 offset:12288
  buffer_load_dwordx4 v14, s[24:27], s57 offen offset:2048 lds
  ds_read_b64_tr_b16 a[192:193], v143 offset:0
  ds_read_b64_tr_b16 a[194:195], v143 offset:512
  ds_read_b64_tr_b16 a[196:197], v141 offset:0
  ds_read_b64_tr_b16 a[198:199], v141 offset:512
  buffer_load_dwordx4 v15, s[24:27], s57 offen offset:3072 lds
  ds_read_b64_tr_b16 a[200:201], v143 offset:1024
  ds_read_b64_tr_b16 a[202:203], v143 offset:1536
  ds_read_b64_tr_b16 a[204:205], v141 offset:1024
  ds_read_b64_tr_b16 a[206:207], v141 offset:1536
  ds_read_b64_tr_b16 a[208:209], v143 offset:3584
  ds_read_b64_tr_b16 a[210:211], v143 offset:4096
  s_add_u32 s56, s59, 0
  s_nop 0
  buffer_load_dwordx4 v[16:19], v2, s[36:39], s56 offen sc1
  ds_read_b64_tr_b16 a[212:213], v141 offset:3584
  ds_read_b64_tr_b16 a[214:215], v141 offset:4096
  ds_read_b64_tr_b16 a[216:217], v143 offset:4608
  buffer_load_dwordx4 v[20:23], v2, s[36:39], s56 offen offset:1024 sc1
  ds_read_b64_tr_b16 a[218:219], v143 offset:5120
  ds_read_b64_tr_b16 a[220:221], v141 offset:4608
  ds_read_b64_tr_b16 a[222:223], v141 offset:5120
  s_add_u32 s56, s59, 2048
  buffer_load_dwordx4 v[24:27], v2, s[36:39], s56 offen sc1
  ds_read_b64_tr_b16 a[224:225], v143 offset:7168
  ds_read_b64_tr_b16 a[226:227], v143 offset:7680
  ds_read_b64_tr_b16 a[228:229], v141 offset:7168
  buffer_load_dwordx4 v[28:31], v2, s[36:39], s56 offen offset:1024 sc1
  ds_read_b64_tr_b16 a[230:231], v141 offset:7680
  ds_read_b64_tr_b16 a[232:233], v143 offset:8192
  ds_read_b64_tr_b16 a[234:235], v143 offset:8704
  s_add_u32 s56, s59, 4096
  buffer_load_dwordx4 v[32:35], v2, s[36:39], s56 offen sc1
  ds_read_b64_tr_b16 a[236:237], v141 offset:8192
  ds_read_b64_tr_b16 a[238:239], v141 offset:8704
  ds_read_b64_tr_b16 a[240:241], v143 offset:10752
  buffer_load_dwordx4 v[36:39], v2, s[36:39], s56 offen offset:1024 sc1
  ds_read_b64_tr_b16 a[242:243], v143 offset:11264
  ds_read_b64_tr_b16 a[244:245], v141 offset:10752
  ds_read_b64_tr_b16 a[246:247], v141 offset:11264
  s_add_u32 s56, s59, 6144
  buffer_load_dwordx4 v[40:43], v2, s[36:39], s56 offen sc1
  ds_read_b64_tr_b16 a[248:249], v143 offset:11776
  ds_read_b64_tr_b16 a[250:251], v143 offset:12288
  ds_read_b64_tr_b16 a[252:253], v141 offset:11776
  buffer_load_dwordx4 v[44:47], v2, s[36:39], s56 offen offset:1024 sc1
  ds_read_b64_tr_b16 a[254:255], v141 offset:12288
  s_waitcnt lgkmcnt(15)
  s_nop 0
  v_accvgpr_write_b32 a139, 0
  v_accvgpr_write_b32 a143, 0
  v_accvgpr_write_b32 a155, 0
  v_accvgpr_write_b32 a159, 0
  v_accvgpr_write_b32 a171, 0
  v_accvgpr_write_b32 a175, 0
  v_accvgpr_write_b32 a187, 0
  v_accvgpr_write_b32 a191, 0
  v_accvgpr_write_b32 a203, 0
  v_accvgpr_write_b32 a207, 0
  v_accvgpr_write_b32 a219, 0
  v_accvgpr_write_b32 a223, 0
  s_waitcnt lgkmcnt(10)
  v_accvgpr_write_b32 a235, 0
  s_waitcnt lgkmcnt(8)
  v_accvgpr_write_b32 a239, 0
  s_waitcnt lgkmcnt(2)
  v_accvgpr_write_b32 a251, 0
  s_waitcnt lgkmcnt(0)
  v_accvgpr_write_b32 a255, 0
  s_mul_i32 s46, s3, 12288
  s_mul_i32 s47, s3, 28672
  v_add_u32 v131, s47, v2
  s_lshl_b32 s71, s61, 1
  s_lshr_b32 s73, s3, 1
  s_add_u32 s71, s71, s73
  s_mul_i32 s70, s69, 14
  s_add_u32 s71, s71, s70
  s_mul_i32 s83, s71, 2432
  s_add_u32 s83, s83, 4456448
  s_lshr_b32 s48, s3, 1
  s_nop 0
  v_bfe_u32 v9, v1, 2, 2
  v_lshl_add_u32 v240, v3, 2, v9
  v_lshlrev_b32 v254, 7, v240
  v_lshlrev_b32 v240, 8, v240
  v_xor_b32 v9, s3, v9
  v_lshl_add_u32 v240, v9, 6, v240
  v_bfe_u32 v9, v1, 4, 1
  v_lshlrev_b32 v9, 5, v9
  v_lshl_add_u32 v9, v8, 3, v9
  v_add_u32 v240, v240, v9
  v_add_u32 v254, v254, v9
  v_bfe_u32 v9, v1, 3, 1
  v_xor_b32 v9, s48, v9
  v_lshl_add_u32 v254, v9, 6, v254
  s_add_u32 s46, s46, 114688
  v_add_u32 v252, s47, v254
  v_xor_b32 v253, 64, v252
  v_add_u32 v254, s46, v254
  v_add_u32 v134, s46, v2
  v_xor_b32 v255, 64, v254
  v_xor_b32_e64 v241, 64, v240
  v_xor_b32 v242, 128, v240
  v_xor_b32 v243, 192, v240
  v_add_u32 v244, 57344, v240
  v_add_u32 v245, 57344, v241
  v_add_u32 v246, 57344, v242
  v_add_u32 v247, 57344, v243
  s_waitcnt lgkmcnt(0)
  s_barrier
  s_add_u32 m0, s41, 81920
  s_add_u32 s57, s40, 1146880
  buffer_load_dwordx4 v12, s[24:27], s57 offen offset:0 lds
  buffer_load_dwordx4 v13, s[24:27], s57 offen offset:1024 lds
  buffer_load_dwordx4 v14, s[24:27], s57 offen offset:2048 lds
  buffer_load_dwordx4 v15, s[24:27], s57 offen offset:3072 lds
  s_add_u32 s56, s50, 0
  buffer_load_dwordx4 v[48:51], v2, s[36:39], s56 offen sc1
  buffer_load_dwordx4 v[52:55], v2, s[36:39], s56 offen offset:1024 sc1
  v_lshlrev_b32 v112, 16, v224
  v_and_b32 v113, s55, v224
  s_add_u32 s56, s50, 2048
  buffer_load_dwordx4 v[56:59], v2, s[36:39], s56 offen sc1
  buffer_load_dwordx4 v[60:63], v2, s[36:39], s56 offen offset:1024 sc1
  v_lshlrev_b32 v114, 16, v225
  v_and_b32 v115, s55, v225
  s_add_u32 s56, s50, 4096
  buffer_load_dwordx4 v[64:67], v2, s[36:39], s56 offen sc1
  buffer_load_dwordx4 v[68:71], v2, s[36:39], s56 offen offset:1024 sc1
  v_lshlrev_b32 v116, 16, v226
  v_and_b32 v117, s55, v226
  s_add_u32 s56, s50, 6144
  buffer_load_dwordx4 v[72:75], v2, s[36:39], s56 offen sc1
  buffer_load_dwordx4 v[76:79], v2, s[36:39], s56 offen offset:1024 sc1
  v_lshlrev_b32 v118, 16, v227
  v_and_b32 v119, s55, v227
  v_lshlrev_b32 v120, 16, v228
  v_and_b32 v121, s55, v228
  v_lshlrev_b32 v122, 16, v229
  v_and_b32 v123, s55, v229
  v_lshlrev_b32 v124, 16, v230
  v_and_b32 v125, s55, v230
  v_lshlrev_b32 v126, 16, v231
  v_and_b32 v127, s55, v231
  s_waitcnt vmcnt(18)
  v_bitop3_b32 v10, v16, v23, s62 bitop3:0x28
  v_cmp_ne_u32 vcc, v10, v6
  s_cbranch_vccnz L_fo_r0
L_fo_ok0:
  v_mfma_f32_32x32x16_bf16 v[96:111], a[132:135], v[16:19], 0
  s_add_u32 m0, s41, 98304
  s_add_u32 s57, s40, 1376256
  buffer_load_dwordx4 v12, s[24:27], s57 offen offset:0 lds
  v_mfma_f32_32x32x16_bf16 v[80:95], a[128:131], v[16:19], v[112:127]
  s_waitcnt vmcnt(17)
  v_bitop3_b32 v10, v24, v31, s62 bitop3:0x28
  v_mfma_f32_32x32x16_bf16 v[96:111], a[140:143], v[20:23], v[96:111]
  v_cmp_ne_u32 vcc, v10, v6
  v_mfma_f32_32x32x16_bf16 v[80:95], a[136:139], v[20:23], v[80:95]
  s_cbranch_vccnz L_fo_r1
L_fo_ok1:
  v_mfma_f32_32x32x16_bf16 v[96:111], a[148:151], v[24:27], v[96:111]
  v_mfma_f32_32x32x16_bf16 v[80:95], a[144:147], v[24:27], v[80:95]
  s_waitcnt vmcnt(15)
  v_bitop3_b32 v10, v32, v39, s62 bitop3:0x28
  v_mfma_f32_32x32x16_bf16 v[96:111], a[156:159], v[28:31], v[96:111]
  v_cmp_ne_u32 vcc, v10, v6
  buffer_load_dwordx4 v13, s[24:27], s57 offen offset:1024 lds
  v_mfma_f32_32x32x16_bf16 v[80:95], a[152:155], v[28:31], v[80:95]
  s_cbranch_vccnz L_fo_r2
L_fo_ok2:
  v_mfma_f32_32x32x16_bf16 v[96:111], a[164:167], v[32:35], v[96:111]
  buffer_load_dwordx4 v14, s[24:27], s57 offen offset:2048 lds
  v_mfma_f32_32x32x16_bf16 v[80:95], a[160:163], v[32:35], v[80:95]
  s_waitcnt vmcnt(15)
  v_bitop3_b32 v10, v40, v47, s62 bitop3:0x28
  v_mfma_f32_32x32x16_bf16 v[96:111], a[172:175], v[36:39], v[96:111]
  v_cmp_ne_u32 vcc, v10, v6
  buffer_load_dwordx4 v15, s[24:27], s57 offen offset:3072 lds
  v_mfma_f32_32x32x16_bf16 v[80:95], a[168:171], v[36:39], v[80:95]
  s_cbranch_vccnz L_fo_r3
L_fo_ok3:
  v_mfma_f32_32x32x16_bf16 v[96:111], a[180:183], v[40:43], v[96:111]
  s_add_u32 s81, s42, 0
  buffer_load_dwordx4 a[0:3], v136, s[28:31], s81 offen offset:0
  v_mfma_f32_32x32x16_bf16 v[80:95], a[176:179], v[40:43], v[80:95]
  s_waitcnt vmcnt(11)
  v_bitop3_b32 v10, v48, v55, s62 bitop3:0x28
  v_mfma_f32_32x32x16_bf16 v[96:111], a[188:191], v[44:47], v[96:111]
  v_cmp_ne_u32 vcc, v10, v6
  v_mfma_f32_32x32x16_bf16 v[80:95], a[184:187], v[44:47], v[80:95]
  s_cbranch_vccnz L_fo_r4
L_fo_ok4:
  v_mfma_f32_32x32x16_bf16 v[96:111], a[196:199], v[48:51], v[96:111]
  buffer_load_dwordx4 a[4:7], v137, s[28:31], s81 offen offset:1024
  v_mfma_f32_32x32x16_bf16 v[80:95], a[192:195], v[48:51], v[80:95]
  s_waitcnt vmcnt(10)
  v_bitop3_b32 v10, v56, v63, s62 bitop3:0x28
  v_mfma_f32_32x32x16_bf16 v[96:111], a[204:207], v[52:55], v[96:111]
  v_cmp_ne_u32 vcc, v10, v6
  buffer_load_dwordx4 a[8:11], v128, s[28:31], s81 offen offset:2048
  v_mfma_f32_32x32x16_bf16 v[80:95], a[200:203], v[52:55], v[80:95]
  s_cbranch_vccnz L_fo_r5
L_fo_ok5:
  v_mfma_f32_32x32x16_bf16 v[96:111], a[212:215], v[56:59], v[96:111]
  buffer_load_dwordx4 a[12:15], v129, s[28:31], s81 offen offset:3072
  v_mfma_f32_32x32x16_bf16 v[80:95], a[208:211], v[56:59], v[80:95]
  s_waitcnt vmcnt(10)
  v_bitop3_b32 v10, v64, v71, s62 bitop3:0x28
  v_mfma_f32_32x32x16_bf16 v[96:111], a[220:223], v[60:63], v[96:111]
  v_cmp_ne_u32 vcc, v10, v6
  s_add_u32 s81, s42, 229376
  buffer_load_dwordx4 a[16:19], v136, s[28:31], s81 offen offset:0
  v_mfma_f32_32x32x16_bf16 v[80:95], a[216:219], v[60:63], v[80:95]
  s_cbranch_vccnz L_fo_r6
L_fo_ok6:
  v_mfma_f32_32x32x16_bf16 v[96:111], a[228:231], v[64:67], v[96:111]
  v_mfma_f32_32x32x16_bf16 v[80:95], a[224:227], v[64:67], v[80:95]
  s_waitcnt vmcnt(9)
  v_bitop3_b32 v10, v72, v79, s62 bitop3:0x28
  v_mfma_f32_32x32x16_bf16 v[96:111], a[236:239], v[68:71], v[96:111]
  v_cmp_ne_u32 vcc, v10, v6
  buffer_load_dwordx4 a[20:23], v137, s[28:31], s81 offen offset:1024
  v_mfma_f32_32x32x16_bf16 v[80:95], a[232:235], v[68:71], v[80:95]
  s_cbranch_vccnz L_fo_r7
L_fo_ok7:
  v_mfma_f32_32x32x16_bf16 v[96:111], a[244:247], v[72:75], v[96:111]
  buffer_load_dwordx4 a[24:27], v128, s[28:31], s81 offen offset:2048
  v_mfma_f32_32x32x16_bf16 v[80:95], a[240:243], v[72:75], v[80:95]
  v_mfma_f32_32x32x16_bf16 v[96:111], a[252:255], v[76:79], v[96:111]
  buffer_load_dwordx4 a[28:31], v129, s[28:31], s81 offen offset:3072
  v_mfma_f32_32x32x16_bf16 v[80:95], a[248:251], v[76:79], v[80:95]
  s_nop 9
  ds_write_b128 v132, v[96:99] offset:0
  ds_write_b128 v132, v[100:103] offset:1024
  ds_write_b128 v132, v[104:107] offset:2048
  ds_write_b128 v132, v[108:111] offset:3072
  v_mov_b32 v112, 0
  v_mov_b32 v113, 0
  s_waitcnt lgkmcnt(0)
  s_barrier
  ds_read_b128 v[96:99], v133 offset:0
  ds_read_b128 v[100:103], v133 offset:1024
  ds_read_b128 v[104:107], v133 offset:2048
  ds_read_b128 v[108:111], v133 offset:3072
  s_waitcnt lgkmcnt(3)
  v_pk_add_f32 v[80:81], v[80:81], v[96:97]
  v_pk_add_f32 v[82:83], v[82:83], v[98:99]
  s_waitcnt lgkmcnt(2)
  s_nop 0
  v_pk_add_f32 v[84:85], v[84:85], v[100:101]
  v_pk_add_f32 v[86:87], v[86:87], v[102:103]
  v_cvt_pk_bf16_f32 v224, v80, v81
  v_cvt_pk_bf16_f32 v225, v82, v83
  v_cvt_pk_bf16_f32 v226, v84, v85
  v_cvt_pk_bf16_f32 v227, v86, v87
  buffer_store_dwordx4 v[224:227], v2, s[36:39], s83 offen sc1
  s_waitcnt lgkmcnt(1)
  v_pk_add_f32 v[88:89], v[88:89], v[104:105]
  v_pk_add_f32 v[90:91], v[90:91], v[106:107]
  s_waitcnt lgkmcnt(0)
  v_pk_add_f32 v[92:93], v[92:93], v[108:109]
  v_pk_add_f32 v[94:95], v[94:95], v[110:111]
  v_cvt_pk_bf16_f32 v228, v88, v89
  v_cvt_pk_bf16_f32 v229, v90, v91
  v_cvt_pk_bf16_f32 v230, v92, v93
  v_cvt_pk_bf16_f32 v231, v94, v95
  buffer_store_dwordx4 v[228:231], v2, s[36:39], s83 offen offset:1024 sc1
  v_dot2c_f32_bf16 v112, s68, v224
  v_dot2c_f32_bf16 v113, v224, v224
  v_dot2c_f32_bf16 v112, s68, v225
  v_dot2c_f32_bf16 v113, v225, v225
  v_dot2c_f32_bf16 v112, s68, v226
  v_dot2c_f32_bf16 v113, v226, v226
  v_dot2c_f32_bf16 v112, s68, v227
  v_dot2c_f32_bf16 v113, v227, v227
  v_dot2c_f32_bf16 v112, s68, v228
  v_dot2c_f32_bf16 v113, v228, v228
  v_dot2c_f32_bf16 v112, s68, v229
  v_dot2c_f32_bf16 v113, v229, v229
  v_dot2c_f32_bf16 v112, s68, v230
  v_dot2c_f32_bf16 v113, v230, v230
  v_dot2c_f32_bf16 v112, s68, v231
  v_dot2c_f32_bf16 v113, v231, v231
  v_bitop3_b32 v10, v224, v228, v5 bitop3:0x96
  s_nop 1
  v_permlane32_swap_b32 v112, v113
  v_add_f32 v112, v112, v113
  buffer_store_dword v112, v4, s[36:39], s83 offen offset:2048 sc1
  v_xor_b32 v113, v10, v112
  buffer_store_short v113, v0, s[36:39], s83 offen offset:2304 sc1
  v_mov_b32 v232, s68
  v_mov_b32 v233, s68
  v_mov_b32 v234, s68
  v_mov_b32 v235, s68
  s_waitcnt vmcnt(12)
  s_barrier
  ds_read_b64_tr_b16 a[224:225], v240 offset:0
  ds_read_b64_tr_b16 a[226:227], v240 offset:2048
  ds_read_b64_tr_b16 a[228:229], v240 offset:4096
  ds_read_b64_tr_b16 a[230:231], v240 offset:6144
  ds_read_b64_tr_b16 a[232:233], v240 offset:8192
  ds_read_b64_tr_b16 a[234:235], v240 offset:10240
  ds_read_b64_tr_b16 a[236:237], v240 offset:12288
  ds_read_b64_tr_b16 a[238:239], v240 offset:14336
  ds_read_b64_tr_b16 a[240:241], v240 offset:16384
  ds_read_b64_tr_b16 a[242:243], v240 offset:18432
  ds_read_b64_tr_b16 a[244:245], v240 offset:20480
  ds_read_b64_tr_b16 a[246:247], v240 offset:22528
  s_waitcnt lgkmcnt(8)
  v_mfma_f32_32x32x16_bf16 v[176:191], v[232:235], a[224:227], 0
  ds_read_b64_tr_b16 a[248:249], v240 offset:24576
  ds_read_b64_tr_b16 a[250:251], v240 offset:26624
  s_lshl_b32 s71, s67, 2
  s_add_u32 m0, s46, 0
  s_add_u32 s57, s42, 458752
  buffer_load_dwordx4 v136, s[28:31], s57 offen offset:0 lds
  s_add_u32 s71, s71, s3
  v_mfma_f32_32x32x16_bf16 v[176:191], v[232:235], a[228:231], v[176:191]
  ds_read_b64_tr_b16 a[252:253], v240 offset:28672
  ds_read_b64_tr_b16 a[254:255], v240 offset:30720
  s_mul_i32 s59, s71, 34048
  s_add_u32 s59, s59, 4456448
  s_waitcnt lgkmcnt(8)
  v_mfma_f32_32x32x16_bf16 v[176:191], v[232:235], a[232:235], v[176:191]
  ds_read_b64_tr_b16 a[224:225], v240 offset:32768
  ds_read_b64_tr_b16 a[226:227], v240 offset:34816
  s_mul_i32 s70, s71, 56
  buffer_load_dwordx4 v137, s[28:31], s57 offen offset:1024 lds
  s_lshl_b32 s73, s7, 2
  v_mfma_f32_32x32x16_bf16 v[176:191], v[232:235], a[236:239], v[176:191]
  ds_read_b64_tr_b16 a[228:229], v240 offset:36864
  ds_read_b64_tr_b16 a[230:231], v240 offset:38912
  buffer_load_dwordx4 v128, s[28:31], s57 offen offset:2048 lds
  s_add_u32 s70, s70, s73
  s_waitcnt lgkmcnt(8)
  v_mfma_f32_32x32x16_bf16 v[176:191], v[232:235], a[240:243], v[176:191]
  ds_read_b64_tr_b16 a[232:233], v240 offset:40960
  ds_read_b64_tr_b16 a[234:235], v240 offset:43008
  s_mul_i32 s63, s70, 2176
  buffer_load_dwordx4 v129, s[28:31], s57 offen offset:3072 lds
  s_add_u32 s63, s63, 6815744
  v_mfma_f32_32x32x16_bf16 v[176:191], v[232:235], a[244:247], v[176:191]
  ds_read_b64_tr_b16 a[236:237], v240 offset:45056
  ds_read_b64_tr_b16 a[238:239], v240 offset:47104
  s_add_u32 m0, s46, 4096
  s_add_u32 s57, s42, 688128
  buffer_load_dwordx4 v136, s[28:31], s57 offen offset:0 lds
  v_lshlrev_b32 v13, 3, v1
  s_lshl_b32 s70, s3, 9
  s_waitcnt lgkmcnt(8)
  v_mfma_f32_32x32x16_bf16 v[176:191], v[232:235], a[248:251], v[176:191]
  ds_read_b64_tr_b16 a[240:241], v240 offset:49152
  ds_read_b64_tr_b16 a[242:243], v240 offset:51200
  s_add_u32 s70, s70, 161792
  v_add_u32 v13, s70, v13
  v_mfma_f32_32x32x16_bf16 v[176:191], v[232:235], a[252:255], v[176:191]
  ds_read_b64_tr_b16 a[244:245], v240 offset:53248
  ds_read_b64_tr_b16 a[246:247], v240 offset:55296
  v_mov_b32 v222, 0
  buffer_load_dwordx4 v137, s[28:31], s57 offen offset:1024 lds
  s_waitcnt lgkmcnt(8)
  v_mfma_f32_32x32x16_bf16 v[176:191], v[232:235], a[224:227], v[176:191]
  ds_read_b64_tr_b16 a[248:249], v244 offset:0
  ds_read_b64_tr_b16 a[250:251], v244 offset:2048
  buffer_load_dwordx4 v128, s[28:31], s57 offen offset:2048 lds
  v_mfma_f32_32x32x16_bf16 v[176:191], v[232:235], a[228:231], v[176:191]
  ds_read_b64_tr_b16 a[252:253], v244 offset:4096
  ds_read_b64_tr_b16 a[254:255], v244 offset:6144
  buffer_load_dwordx4 v129, s[28:31], s57 offen offset:3072 lds
  s_waitcnt lgkmcnt(8)
  v_mfma_f32_32x32x16_bf16 v[176:191], v[232:235], a[232:235], v[176:191]
  ds_read_b64_tr_b16 a[224:225], v244 offset:8192
  ds_read_b64_tr_b16 a[226:227], v244 offset:10240
  v_mfma_f32_32x32x16_bf16 v[176:191], v[232:235], a[236:239], v[176:191]
  ds_read_b64_tr_b16 a[228:229], v244 offset:12288
  ds_read_b64_tr_b16 a[230:231], v244 offset:14336
  s_waitcnt lgkmcnt(8)
  v_mfma_f32_32x32x16_bf16 v[176:191], v[232:235], a[240:243], v[176:191]
  ds_read_b64_tr_b16 a[232:233], v244 offset:16384
  ds_read_b64_tr_b16 a[234:235], v244 offset:18432
  v_mfma_f32_32x32x16_bf16 v[176:191], v[232:235], a[244:247], v[176:191]
  ds_read_b64_tr_b16 a[236:237], v244 offset:20480
  ds_read_b64_tr_b16 a[238:239], v244 offset:22528
  s_waitcnt lgkmcnt(8)
  v_mfma_f32_32x32x16_bf16 v[176:191], v[232:235], a[248:251], v[176:191]
  ds_read_b64_tr_b16 a[240:241], v244 offset:24576
  ds_read_b64_tr_b16 a[242:243], v244 offset:26624
  v_mfma_f32_32x32x16_bf16 v[176:191], v[232:235], a[252:255], v[176:191]
  ds_read_b64_tr_b16 a[244:245], v244 offset:28672
  ds_read_b64_tr_b16 a[246:247], v244 offset:30720
  s_waitcnt lgkmcnt(8)
  v_mfma_f32_32x32x16_bf16 v[176:191], v[232:235], a[224:227], v[176:191]
  ds_read_b64_tr_b16 a[248:249], v244 offset:32768
  ds_read_b64_tr_b16 a[250:251], v244 offset:34816
  v_mfma_f32_32x32x16_bf16 v[176:191], v[232:235], a[228:231], v[176:191]
  ds_read_b64_tr_b16 a[252:253], v244 offset:36864
  ds_read_b64_tr_b16 a[254:255], v244 offset:38912
  s_waitcnt lgkmcnt(8)
  v_mfma_f32_32x32x16_bf16 v[176:191], v[232:235], a[232:235], v[176:191]
  ds_read_b64_tr_b16 a[224:225], v244 offset:40960
  ds_read_b64_tr_b16 a[226:227], v244 offset:43008
  v_mfma_f32_32x32x16_bf16 v[176:191], v[232:235], a[236:239], v[176:191]
  ds_read_b64_tr_b16 a[228:229], v244 offset:45056
  ds_read_b64_tr_b16 a[230:231], v244 offset:47104
  s_waitcnt lgkmcnt(8)
  v_mfma_f32_32x32x16_bf16 v[176:191], v[232:235], a[240:243], v[176:191]
  ds_read_b64_tr_b16 a[232:233], v244 offset:49152
  ds_read_b64_tr_b16 a[234:235], v244 offset:51200
  v_mfma_f32_32x32x16_bf16 v[176:191], v[232:235], a[244:247], v[176:191]
  ds_read_b64_tr_b16 a[236:237], v244 offset:53248
  ds_read_b64_tr_b16 a[238:239], v244 offset:55296
  s_waitcnt lgkmcnt(8)
  v_mfma_f32_32x32x16_bf16 v[176:191], v[232:235], a[248:251], v[176:191]
  ds_read_b64_tr_b16 a[240:241], v240 offset:0
  ds_read_b64_tr_b16 a[242:243], v240 offset:2048
  v_mfma_f32_32x32x16_bf16 v[176:191], v[232:235], a[252:255], v[176:191]
  ds_read_b64_tr_b16 a[244:245], v241 offset:0
  ds_read_b64_tr_b16 a[246:247], v241 offset:2048
  s_waitcnt lgkmcnt(8)
  v_mfma_f32_32x32x16_bf16 v[176:191], v[232:235], a[224:227], v[176:191]
  ds_read_b64_tr_b16 a[248:249], v242 offset:0
  ds_read_b64_tr_b16 a[250:251], v242 offset:2048
  v_mfma_f32_32x32x16_bf16 v[176:191], v[232:235], a[228:231], v[176:191]
  ds_read_b64_tr_b16 a[252:253], v240 offset:4096
  ds_read_b64_tr_b16 a[254:255], v240 offset:6144
  s_waitcnt lgkmcnt(8)
  v_mfma_f32_32x32x16_bf16 v[176:191], v[232:235], a[232:235], v[176:191]
  ds_read_b64_tr_b16 a[224:225], v241 offset:4096
  ds_read_b64_tr_b16 a[226:227], v241 offset:6144
  s_add_u32 s56, s59, 0
  s_nop 0
  buffer_load_dwordx4 v[16:19], v2, s[36:39], s56 offen sc1
  buffer_load_dwordx4 v[20:23], v2, s[36:39], s56 offen offset:1024 sc1
  buffer_load_dword v192, v4, s[36:39], s56 offen offset:2048 sc1
  buffer_load_ushort v193, v0, s[36:39], s56 offen offset:2304 sc1
  s_add_u32 s56, s59, 2432
  buffer_load_dwordx4 v[24:27], v2, s[36:39], s56 offen sc1
  buffer_load_dwordx4 v[28:31], v2, s[36:39], s56 offen offset:1024 sc1
  buffer_load_dword v194, v4, s[36:39], s56 offen offset:2048 sc1
  buffer_load_ushort v195, v0, s[36:39], s56 offen offset:2304 sc1
  s_add_u32 s56, s59, 4864
  buffer_load_dwordx4 v[32:35], v2, s[36:39], s56 offen sc1
  buffer_load_dwordx4 v[36:39], v2, s[36:39], s56 offen offset:1024 sc1
  buffer_load_dword v196, v4, s[36:39], s56 offen offset:2048 sc1
  buffer_load_ushort v197, v0, s[36:39], s56 offen offset:2304 sc1
  s_add_u32 s56, s59, 7296
  buffer_load_dwordx4 v[40:43], v2, s[36:39], s56 offen sc1
  buffer_load_dwordx4 v[44:47], v2, s[36:39], s56 offen offset:1024 sc1
  buffer_load_dword v198, v4, s[36:39], s56 offen offset:2048 sc1
  buffer_load_ushort v199, v0, s[36:39], s56 offen offset:2304 sc1
  v_mfma_f32_32x32x16_bf16 v[176:191], v[232:235], a[236:239], v[176:191]
  ds_read_b64_tr_b16 a[228:229], v242 offset:4096
  ds_read_b64_tr_b16 a[230:231], v242 offset:6144
  s_nop 9
  v_cvt_pk_bf16_f32 v232, v176, v176
  v_lshlrev_b32 v233, 16, v232
  v_sub_f32 v233, v176, v233
  v_cvt_pk_bf16_f32 v232, v176, v233
  v_and_b32 v233, 0xffff, v232
  v_cndmask_b32 v232, v232, 0, s[64:65]
  v_cndmask_b32 v233, v233, 0, s[64:65]
  ds_write_b64 v13, v[232:233]
  s_waitcnt vmcnt(13)
  v_bitop3_b32 v10, v16, v20, v192 bitop3:0x96
  s_waitcnt vmcnt(12)
  v_xor_b32 v10, v10, v193
  v_cmp_ne_u16 vcc, v10, v5
  s_cbranch_vccnz L_fh_r0
L_fh_ok0:
  s_waitcnt lgkmcnt(9)
  v_mfma_f32_32x32x16_bf16 v[144:159], a[240:243], v[16:19], 0
  ds_read_b64_tr_b16 a[232:233], v240 offset:8192
  ds_read_b64_tr_b16 a[234:235], v240 offset:10240
  v_add_f32 v222, v222, v192
  s_add_u32 s56, s59, 9728
  buffer_load_dwordx4 v[48:51], v2, s[36:39], s56 offen sc1
  v_mfma_f32_32x32x16_bf16 v[160:175], a[244:247], v[16:19], 0
  ds_read_b64_tr_b16 a[236:237], v241 offset:8192
  ds_read_b64_tr_b16 a[238:239], v241 offset:10240
  s_waitcnt vmcnt(10)
  v_bitop3_b32 v10, v24, v28, v194 bitop3:0x96
  s_waitcnt lgkmcnt(9)
  v_mfma_f32_32x32x16_bf16 v[176:191], a[248:251], v[16:19], 0
  ds_read_b64_tr_b16 a[240:241], v242 offset:8192
  ds_read_b64_tr_b16 a[242:243], v242 offset:10240
  buffer_load_dwordx4 v[52:55], v2, s[36:39], s56 offen offset:1024 sc1
  s_waitcnt vmcnt(10)
  v_xor_b32 v10, v10, v195
  v_mfma_f32_32x32x16_bf16 v[144:159], a[252:255], v[20:23], v[144:159]
  ds_read_b64_tr_b16 a[244:245], v240 offset:12288
  ds_read_b64_tr_b16 a[246:247], v240 offset:14336
  v_cmp_ne_u16 vcc, v10, v5
  s_waitcnt lgkmcnt(9)
  v_mfma_f32_32x32x16_bf16 v[160:175], a[224:227], v[20:23], v[160:175]
  ds_read_b64_tr_b16 a[248:249], v241 offset:12288
  ds_read_b64_tr_b16 a[250:251], v241 offset:14336
  buffer_load_dword v200, v4, s[36:39], s56 offen offset:2048 sc1
  buffer_load_ushort v201, v0, s[36:39], s56 offen offset:2304 sc1
  s_cbranch_vccnz L_fh_r1
L_fh_ok1:
  v_mfma_f32_32x32x16_bf16 v[176:191], a[228:231], v[20:23], v[176:191]
  ds_read_b64_tr_b16 a[252:253], v242 offset:12288
  ds_read_b64_tr_b16 a[254:255], v242 offset:14336
  s_waitcnt lgkmcnt(8)
  v_mfma_f32_32x32x16_bf16 v[144:159], a[232:235], v[24:27], v[144:159]
  ds_read_b64_tr_b16 a[224:225], v240 offset:16384
  ds_read_b64_tr_b16 a[226:227], v240 offset:18432
  v_add_f32 v222, v222, v194
  s_add_u32 s56, s59, 12160
  buffer_load_dwordx4 v[56:59], v2, s[36:39], s56 offen sc1
  v_mfma_f32_32x32x16_bf16 v[160:175], a[236:239], v[24:27], v[160:175]
  ds_read_b64_tr_b16 a[228:229], v241 offset:16384
  ds_read_b64_tr_b16 a[230:231], v241 offset:18432
  s_waitcnt vmcnt(10)
  v_bitop3_b32 v10, v32, v36, v196 bitop3:0x96
  s_waitcnt lgkmcnt(8)
  v_mfma_f32_32x32x16_bf16 v[176:191], a[240:243], v[24:27], v[176:191]
  ds_read_b64_tr_b16 a[232:233], v242 offset:16384
  ds_read_b64_tr_b16 a[234:235], v242 offset:18432
  buffer_load_dwordx4 v[60:63], v2, s[36:39], s56 offen offset:1024 sc1
  s_waitcnt vmcnt(10)
  v_xor_b32 v10, v10, v197
  v_mfma_f32_32x32x16_bf16 v[144:159], a[244:247], v[28:31], v[144:159]
  ds_read_b64_tr_b16 a[236:237], v240 offset:20480
  ds_read_b64_tr_b16 a[238:239], v240 offset:22528
  v_cmp_ne_u16 vcc, v10, v5
  s_waitcnt lgkmcnt(8)
  v_mfma_f32_32x32x16_bf16 v[160:175], a[248:251], v[28:31], v[160:175]
  ds_read_b64_tr_b16 a[240:241], v241 offset:20480
  ds_read_b64_tr_b16 a[242:243], v241 offset:22528
  buffer_load_dword v202, v4, s[36:39], s56 offen offset:2048 sc1
  buffer_load_ushort v203, v0, s[36:39], s56 offen offset:2304 sc1
  s_cbranch_vccnz L_fh_r2
L_fh_ok2:
  v_mfma_f32_32x32x16_bf16 v[176:191], a[252:255], v[28:31], v[176:191]
  ds_read_b64_tr_b16 a[244:245], v242 offset:20480
  ds_read_b64_tr_b16 a[246:247], v242 offset:22528
  s_waitcnt lgkmcnt(8)
  v_mfma_f32_32x32x16_bf16 v[144:159], a[224:227], v[32:35], v[144:159]
  ds_read_b64_tr_b16 a[248:249], v240 offset:24576
  ds_read_b64_tr_b16 a[250:251], v240 offset:26624
  v_add_f32 v222, v222, v196
  s_add_u32 s56, s59, 14592
  buffer_load_dwordx4 v[64:67], v2, s[36:39], s56 offen sc1
  v_mfma_f32_32x32x16_bf16 v[160:175], a[228:231], v[32:35], v[160:175]
  ds_read_b64_tr_b16 a[252:253], v241 offset:24576
  ds_read_b64_tr_b16 a[254:255], v241 offset:26624
  s_waitcnt vmcnt(10)
  v_bitop3_b32 v10, v40, v44, v198 bitop3:0x96
  s_waitcnt lgkmcnt(8)
  v_mfma_f32_32x32x16_bf16 v[176:191], a[232:235], v[32:35], v[176:191]
  ds_read_b64_tr_b16 a[224:225], v242 offset:24576
  ds_read_b64_tr_b16 a[226:227], v242 offset:26624
  s_barrier
  s_nop 0
  v_xor_b32 v9, 512, v13
  ds_read_b64 v[234:235], v9
  v_xor_b32 v9, 1024, v13
  ds_read_b64 v[236:237], v9
  v_xor_b32 v9, 1536, v13
  ds_read_b64 v[238:239], v9
  buffer_load_dwordx4 v[68:71], v2, s[36:39], s56 offen offset:1024 sc1
  s_waitcnt vmcnt(10)
  v_xor_b32 v10, v10, v199
  v_mfma_f32_32x32x16_bf16 v[144:159], a[236:239], v[36:39], v[144:159]
  ds_read_b64_tr_b16 a[228:229], v240 offset:28672
  ds_read_b64_tr_b16 a[230:231], v240 offset:30720
  v_cmp_ne_u16 vcc, v10, v5
  s_waitcnt lgkmcnt(11)
  v_mfma_f32_32x32x16_bf16 v[160:175], a[240:243], v[36:39], v[160:175]
  ds_read_b64_tr_b16 a[232:233], v241 offset:28672
  ds_read_b64_tr_b16 a[234:235], v241 offset:30720
  buffer_load_dword v204, v4, s[36:39], s56 offen offset:2048 sc1
  buffer_load_ushort v205, v0, s[36:39], s56 offen offset:2304 sc1
  s_cbranch_vccnz L_fh_r3
L_fh_ok3:
  v_mfma_f32_32x32x16_bf16 v[176:191], a[244:247], v[36:39], v[176:191]
  ds_read_b64_tr_b16 a[236:237], v242 offset:28672
  ds_read_b64_tr_b16 a[238:239], v242 offset:30720
  s_waitcnt lgkmcnt(11)
  v_mfma_f32_32x32x16_bf16 v[144:159], a[248:251], v[40:43], v[144:159]
  ds_read_b64_tr_b16 a[240:241], v240 offset:32768
  ds_read_b64_tr_b16 a[242:243], v240 offset:34816
  v_add_f32 v222, v222, v198
  s_add_u32 s56, s59, 17024
  buffer_load_dwordx4 v[72:75], v2, s[36:39], s56 offen sc1
  v_mfma_f32_32x32x16_bf16 v[160:175], a[252:255], v[40:43], v[160:175]
  ds_read_b64_tr_b16 a[244:245], v241 offset:32768
  ds_read_b64_tr_b16 a[246:247], v241 offset:34816
  s_waitcnt vmcnt(10)
  v_bitop3_b32 v10, v48, v52, v200 bitop3:0x96
  s_waitcnt lgkmcnt(8)
  v_mfma_f32_32x32x16_bf16 v[176:191], a[224:227], v[40:43], v[176:191]
  ds_read_b64_tr_b16 a[248:249], v242 offset:32768
  ds_read_b64_tr_b16 a[250:251], v242 offset:34816
  buffer_load_dwordx4 v[76:79], v2, s[36:39], s56 offen offset:1024 sc1
  s_waitcnt vmcnt(10)
  v_xor_b32 v10, v10, v201
  v_mfma_f32_32x32x16_bf16 v[144:159], a[228:231], v[44:47], v[144:159]
  ds_read_b64_tr_b16 a[252:253], v240 offset:36864
  ds_read_b64_tr_b16 a[254:255], v240 offset:38912
  v_cmp_ne_u16 vcc, v10, v5
  s_waitcnt lgkmcnt(8)
  v_mfma_f32_32x32x16_bf16 v[160:175], a[232:235], v[44:47], v[160:175]
  ds_read_b64_tr_b16 a[224:225], v241 offset:36864
  ds_read_b64_tr_b16 a[226:227], v241 offset:38912
  buffer_load_dword v206, v4, s[36:39], s56 offen offset:2048 sc1
  buffer_load_ushort v207, v0, s[36:39], s56 offen offset:2304 sc1
  ds_read_b64_tr_b16 a[32:33], v254 offset:0
  s_cbranch_vccnz L_fh_r4
L_fh_ok4:
  ds_read_b64_tr_b16 a[34:35], v254 offset:1024
  v_mfma_f32_32x32x16_bf16 v[176:191], a[236:239], v[44:47], v[176:191]
  ds_read_b64_tr_b16 a[228:229], v242 offset:36864
  ds_read_b64_tr_b16 a[230:231], v242 offset:38912
  ds_read_b64_tr_b16 a[36:37], v255 offset:0
  ds_read_b64_tr_b16 a[38:39], v255 offset:1024
  s_waitcnt lgkmcnt(12)
  v_mfma_f32_32x32x16_bf16 v[144:159], a[240:243], v[48:51], v[144:159]
  ds_read_b64_tr_b16 a[232:233], v240 offset:40960
  ds_read_b64_tr_b16 a[234:235], v240 offset:43008
  v_add_f32 v222, v222, v200
  ds_read_b64_tr_b16 a[40:41], v254 offset:2048
  s_add_u32 s56, s59, 19456
  buffer_load_dwordx4 v[80:83], v2, s[36:39], s56 offen sc1
  ds_read_b64_tr_b16 a[42:43], v254 offset:3072
  ds_read_b64_tr_b16 a[44:45], v255 offset:2048
  v_mfma_f32_32x32x16_bf16 v[160:175], a[244:247], v[48:51], v[160:175]
  ds_read_b64_tr_b16 a[236:237], v241 offset:40960
  ds_read_b64_tr_b16 a[238:239], v241 offset:43008
  s_waitcnt vmcnt(10)
  v_bitop3_b32 v10, v56, v60, v202 bitop3:0x96
  ds_read_b64_tr_b16 a[46:47], v255 offset:3072
  s_waitcnt lgkmcnt(15)
  v_mfma_f32_32x32x16_bf16 v[176:191], a[248:251], v[48:51], v[176:191]
  ds_read_b64_tr_b16 a[240:241], v242 offset:40960
  ds_read_b64_tr_b16 a[242:243], v242 offset:43008
  buffer_load_dwordx4 v[84:87], v2, s[36:39], s56 offen offset:1024 sc1
  ds_read_b64_tr_b16 a[48:49], v254 offset:4096
  s_waitcnt vmcnt(10)
  v_xor_b32 v10, v10, v203
  ds_read_b64_tr_b16 a[50:51], v254 offset:5120
  v_mfma_f32_32x32x16_bf16 v[144:159], a[252:255], v[52:55], v[144:159]
  ds_read_b64_tr_b16 a[244:245], v240 offset:45056
  ds_read_b64_tr_b16 a[246:247], v240 offset:47104
  ds_read_b64_tr_b16 a[52:53], v255 offset:4096
  v_cmp_ne_u16 vcc, v10, v5
  ds_read_b64_tr_b16 a[54:55], v255 offset:5120
  ds_read_b64_tr_b16 a[56:57], v254 offset:6144
  s_waitcnt lgkmcnt(15)
  v_mfma_f32_32x32x16_bf16 v[160:175], a[224:227], v[52:55], v[160:175]
  ds_read_b64_tr_b16 a[248:249], v241 offset:45056
  ds_read_b64_tr_b16 a[250:251], v241 offset:47104
  buffer_load_dword v208, v4, s[36:39], s56 offen offset:2048 sc1
  buffer_load_ushort v209, v0, s[36:39], s56 offen offset:2304 sc1
  ds_read_b64_tr_b16 a[58:59], v254 offset:7168
  s_cbranch_vccnz L_fh_r5
L_fh_ok5:
  ds_read_b64_tr_b16 a[60:61], v255 offset:6144
  v_mfma_f32_32x32x16_bf16 v[176:191], a[228:231], v[52:55], v[176:191]
  ds_read_b64_tr_b16 a[252:253], v242 offset:45056
  ds_read_b64_tr_b16 a[254:255], v242 offset:47104
  ds_read_b64_tr_b16 a[62:63], v255 offset:7168
  ds_write_b128 v134, a[0:3] offset:0
  s_waitcnt lgkmcnt(15)
  v_mfma_f32_32x32x16_bf16 v[144:159], a[232:235], v[56:59], v[144:159]
  ds_read_b64_tr_b16 a[224:225], v240 offset:49152
  ds_read_b64_tr_b16 a[226:227], v240 offset:51200
  v_add_f32 v222, v222, v202
  s_add_u32 s56, s59, 21888
  buffer_load_dwordx4 v[88:91], v2, s[36:39], s56 offen sc1
  v_mfma_f32_32x32x16_bf16 v[160:175], a[236:239], v[56:59], v[160:175]
  ds_read_b64_tr_b16 a[228:229], v241 offset:49152
  ds_read_b64_tr_b16 a[230:231], v241 offset:51200
  s_waitcnt vmcnt(10)
  v_bitop3_b32 v10, v64, v68, v204 bitop3:0x96
  s_waitcnt lgkmcnt(15)
  v_mfma_f32_32x32x16_bf16 v[176:191], a[240:243], v[56:59], v[176:191]
  ds_read_b64_tr_b16 a[232:233], v242 offset:49152
  ds_read_b64_tr_b16 a[234:235], v242 offset:51200
  buffer_load_dwordx4 v[92:95], v2, s[36:39], s56 offen offset:1024 sc1
  s_waitcnt vmcnt(10)
  v_xor_b32 v10, v10, v205
  ds_write_b128 v134, a[4:7] offset:1024
  v_mfma_f32_32x32x16_bf16 v[144:159], a[244:247], v[60:63], v[144:159]
  ds_read_b64_tr_b16 a[236:237], v240 offset:53248
  ds_read_b64_tr_b16 a[238:239], v240 offset:55296
  v_cmp_ne_u16 vcc, v10, v5
  s_waitcnt lgkmcnt(11)
  v_mfma_f32_32x32x16_bf16 v[160:175], a[248:251], v[60:63], v[160:175]
  ds_read_b64_tr_b16 a[240:241], v241 offset:53248
  ds_read_b64_tr_b16 a[242:243], v241 offset:55296
  buffer_load_dword v210, v4, s[36:39], s56 offen offset:2048 sc1
  buffer_load_ushort v211, v0, s[36:39], s56 offen offset:2304 sc1
  s_cbranch_vccnz L_fh_r6
L_fh_ok6:
  v_mfma_f32_32x32x16_bf16 v[176:191], a[252:255], v[60:63], v[176:191]
  ds_read_b64_tr_b16 a[244:245], v242 offset:53248
  ds_read_b64_tr_b16 a[246:247], v242 offset:55296
  ds_write_b128 v134, a[8:11] offset:2048
  s_waitcnt lgkmcnt(10)
  v_mfma_f32_32x32x16_bf16 v[144:159], a[224:227], v[64:67], v[144:159]
  ds_read_b64_tr_b16 a[248:249], v244 offset:0
  ds_read_b64_tr_b16 a[250:251], v244 offset:2048
  v_add_f32 v222, v222, v204
  s_add_u32 s56, s59, 24320
  buffer_load_dwordx4 v[96:99], v2, s[36:39], s56 offen sc1
  v_mfma_f32_32x32x16_bf16 v[160:175], a[228:231], v[64:67], v[160:175]
  ds_read_b64_tr_b16 a[252:253], v245 offset:0
  ds_read_b64_tr_b16 a[254:255], v245 offset:2048
  s_waitcnt vmcnt(10)
  v_bitop3_b32 v10, v72, v76, v206 bitop3:0x96
  ds_write_b128 v134, a[12:15] offset:3072
  s_waitcnt lgkmcnt(10)
  v_mfma_f32_32x32x16_bf16 v[176:191], a[232:235], v[64:67], v[176:191]
  ds_read_b64_tr_b16 a[224:225], v246 offset:0
  ds_read_b64_tr_b16 a[226:227], v246 offset:2048
  buffer_load_dwordx4 v[100:103], v2, s[36:39], s56 offen offset:1024 sc1
  s_waitcnt vmcnt(10)
  v_xor_b32 v10, v10, v207
  v_mfma_f32_32x32x16_bf16 v[144:159], a[236:239], v[68:71], v[144:159]
  ds_read_b64_tr_b16 a[228:229], v244 offset:4096
  ds_read_b64_tr_b16 a[230:231], v244 offset:6144
  v_cmp_ne_u16 vcc, v10, v5
  s_waitcnt lgkmcnt(10)
  v_mfma_f32_32x32x16_bf16 v[160:175], a[240:243], v[68:71], v[160:175]
  ds_read_b64_tr_b16 a[232:233], v245 offset:4096
  ds_read_b64_tr_b16 a[234:235], v245 offset:6144
  buffer_load_dword v212, v4, s[36:39], s56 offen offset:2048 sc1
  buffer_load_ushort v213, v0, s[36:39], s56 offen offset:2304 sc1
  ds_read_b64_tr_b16 a[0:1], v254 offset:0
  s_cbranch_vccnz L_fh_r7
L_fh_ok7:
  ds_read_b64_tr_b16 a[2:3], v254 offset:1024
  v_mfma_f32_32x32x16_bf16 v[176:191], a[244:247], v[68:71], v[176:191]
  ds_read_b64_tr_b16 a[236:237], v246 offset:4096
  ds_read_b64_tr_b16 a[238:239], v246 offset:6144
  ds_read_b64_tr_b16 a[4:5], v255 offset:0
  ds_read_b64_tr_b16 a[6:7], v255 offset:1024
  s_waitcnt lgkmcnt(13)
  v_mfma_f32_32x32x16_bf16 v[144:159], a[248:251], v[72:75], v[144:159]
  ds_read_b64_tr_b16 a[240:241], v244 offset:8192
  ds_read_b64_tr_b16 a[242:243], v244 offset:10240
  v_add_f32 v222, v222, v206
  s_mul_i32 s70, s69, 56
  ds_read_b64_tr_b16 a[8:9], v254 offset:2048
  s_add_u32 s56, s59, 26752
  buffer_load_dwordx4 v[104:107], v2, s[36:39], s56 offen sc1
  ds_read_b64_tr_b16 a[10:11], v254 offset:3072
  s_xor_b32 s71, s69, 1
  ds_read_b64_tr_b16 a[12:13], v255 offset:2048
  v_mfma_f32_32x32x16_bf16 v[160:175], a[252:255], v[72:75], v[160:175]
  ds_read_b64_tr_b16 a[244:245], v245 offset:8192
  ds_read_b64_tr_b16 a[246:247], v245 offset:10240
  s_waitcnt vmcnt(10)
  v_bitop3_b32 v10, v80, v84, v208 bitop3:0x96
  s_mul_i32 s71, s71, 56
  ds_read_b64_tr_b16 a[14:15], v255 offset:3072
  ds_write_b128 v134, a[16:19] offset:4096
  s_waitcnt lgkmcnt(15)
  v_mfma_f32_32x32x16_bf16 v[176:191], a[224:227], v[72:75], v[176:191]
  ds_read_b64_tr_b16 a[248:249], v246 offset:8192
  ds_read_b64_tr_b16 a[250:251], v246 offset:10240
  s_barrier
  s_add_u32 s51, s71, s44
  buffer_load_dwordx4 v[108:111], v2, s[36:39], s56 offen offset:1024 sc1
  s_waitcnt vmcnt(10)
  v_xor_b32 v10, v10, v209
  s_add_u32 s52, s70, s44
  v_mfma_f32_32x32x16_bf16 v[144:159], a[228:231], v[76:79], v[144:159]
  ds_read_b64_tr_b16 a[252:253], v244 offset:12288
  ds_read_b64_tr_b16 a[254:255], v244 offset:14336
  s_add_u32 s53, s71, s45
  v_cmp_ne_u16 vcc, v10, v5
  s_waitcnt lgkmcnt(15)
  v_mfma_f32_32x32x16_bf16 v[160:175], a[232:235], v[76:79], v[160:175]
  ds_read_b64_tr_b16 a[224:225], v245 offset:12288
  ds_read_b64_tr_b16 a[226:227], v245 offset:14336
  s_add_u32 s54, s70, s45
  buffer_load_dword v214, v4, s[36:39], s56 offen offset:2048 sc1
  buffer_load_ushort v215, v0, s[36:39], s56 offen offset:2304 sc1
  ds_write_b128 v134, a[20:23] offset:5120
  s_mul_i32 s51, s51, 2176
  s_cbranch_vccnz L_fh_r8
L_fh_ok8:
  v_mfma_f32_32x32x16_bf16 v[176:191], a[236:239], v[76:79], v[176:191]
  ds_read_b64_tr_b16 a[228:229], v246 offset:12288
  ds_read_b64_tr_b16 a[230:231], v246 offset:14336
  s_add_u32 s51, s51, 6815744
  s_waitcnt lgkmcnt(11)
  v_mfma_f32_32x32x16_bf16 v[144:159], a[240:243], v[80:83], v[144:159]
  ds_read_b64_tr_b16 a[232:233], v244 offset:16384
  ds_read_b64_tr_b16 a[234:235], v244 offset:18432
  v_add_f32 v222, v222, v208
  s_mul_i32 s52, s52, 2176
  s_add_u32 s56, s59, 29184
  buffer_load_dwordx4 v[112:115], v2, s[36:39], s56 offen sc1
  s_add_u32 s52, s52, 6815744
  v_mfma_f32_32x32x16_bf16 v[160:175], a[244:247], v[80:83], v[160:175]
  ds_read_b64_tr_b16 a[236:237], v245 offset:16384
  ds_read_b64_tr_b16 a[238:239], v245 offset:18432
  s_waitcnt vmcnt(10)
  v_bitop3_b32 v10, v88, v92, v210 bitop3:0x96
  ds_write_b128 v134, a[24:27] offset:6144
  s_mul_i32 s53, s53, 2176
  s_waitcnt lgkmcnt(10)
  v_mfma_f32_32x32x16_bf16 v[176:191], a[248:251], v[80:83], v[176:191]
  ds_read_b64_tr_b16 a[240:241], v246 offset:16384
  ds_read_b64_tr_b16 a[242:243], v246 offset:18432
  s_add_u32 s53, s53, 6815744
  buffer_load_dwordx4 v[116:119], v2, s[36:39], s56 offen offset:1024 sc1
  s_waitcnt vmcnt(10)
  v_xor_b32 v10, v10, v211
  s_mul_i32 s54, s54, 2176
  v_mfma_f32_32x32x16_bf16 v[144:159], a[252:255], v[84:87], v[144:159]
  ds_read_b64_tr_b16 a[244:245], v244 offset:20480
  ds_read_b64_tr_b16 a[246:247], v244 offset:22528
  s_add_u32 s54, s54, 6815744
  v_cmp_ne_u16 vcc, v10, v5
  ds_write_b128 v134, a[28:31] offset:7168
  s_waitcnt lgkmcnt(10)
  v_mfma_f32_32x32x16_bf16 v[160:175], a[224:227], v[84:87], v[160:175]
  ds_read_b64_tr_b16 a[248:249], v245 offset:20480
  ds_read_b64_tr_b16 a[250:251], v245 offset:22528
  buffer_load_dword v216, v4, s[36:39], s56 offen offset:2048 sc1
  buffer_load_ushort v217, v0, s[36:39], s56 offen offset:2304 sc1
  s_cbranch_vccnz L_fh_r9
L_fh_ok9:
  v_mfma_f32_32x32x16_bf16 v[176:191], a[228:231], v[84:87], v[176:191]
  ds_read_b64_tr_b16 a[252:253], v246 offset:20480
  ds_read_b64_tr_b16 a[254:255], v246 offset:22528
  s_waitcnt lgkmcnt(10)
  v_mfma_f32_32x32x16_bf16 v[144:159], a[232:235], v[88:91], v[144:159]
  ds_read_b64_tr_b16 a[224:225], v244 offset:24576
  ds_read_b64_tr_b16 a[226:227], v244 offset:26624
  v_add_f32 v222, v222, v210
  s_add_u32 s56, s59, 31616
  buffer_load_dwordx4 v[120:123], v2, s[36:39], s56 offen sc1
  ds_read_b64_tr_b16 a[16:17], v254 offset:4096
  ds_read_b64_tr_b16 a[18:19], v254 offset:5120
  v_mfma_f32_32x32x16_bf16 v[160:175], a[236:239], v[88:91], v[160:175]
  ds_read_b64_tr_b16 a[228:229], v245 offset:24576
  ds_read_b64_tr_b16 a[230:231], v245 offset:26624
  s_waitcnt vmcnt(10)
  v_bitop3_b32 v10, v96, v100, v212 bitop3:0x96
  ds_read_b64_tr_b16 a[20:21], v255 offset:4096
  ds_read_b64_tr_b16 a[22:23], v255 offset:5120
  s_waitcnt lgkmcnt(13)
  v_mfma_f32_32x32x16_bf16 v[176:191], a[240:243], v[88:91], v[176:191]
  ds_read_b64_tr_b16 a[232:233], v246 offset:24576
  ds_read_b64_tr_b16 a[234:235], v246 offset:26624
  buffer_load_dwordx4 v[124:127], v2, s[36:39], s56 offen offset:1024 sc1
  s_waitcnt vmcnt(10)
  v_xor_b32 v10, v10, v213
  ds_read_b64_tr_b16 a[24:25], v254 offset:6144
  ds_read_b64_tr_b16 a[26:27], v254 offset:7168
  v_mfma_f32_32x32x16_bf16 v[144:159], a[244:247], v[92:95], v[144:159]
  ds_read_b64_tr_b16 a[236:237], v244 offset:28672
  ds_read_b64_tr_b16 a[238:239], v244 offset:30720
  ds_read_b64_tr_b16 a[28:29], v255 offset:6144
  v_cmp_ne_u16 vcc, v10, v5
  ds_read_b64_tr_b16 a[30:31], v255 offset:7168
  s_waitcnt lgkmcnt(15)
  v_mfma_f32_32x32x16_bf16 v[160:175], a[248:251], v[92:95], v[160:175]
  ds_read_b64_tr_b16 a[240:241], v245 offset:28672
  ds_read_b64_tr_b16 a[242:243], v245 offset:30720
  buffer_load_dword v218, v4, s[36:39], s56 offen offset:2048 sc1
  buffer_load_ushort v219, v0, s[36:39], s56 offen offset:2304 sc1
  s_cbranch_vccnz L_fh_r10
L_fh_ok10:
  v_mfma_f32_32x32x16_bf16 v[176:191], a[252:255], v[92:95], v[176:191]
  ds_read_b64_tr_b16 a[244:245], v246 offset:28672
  ds_read_b64_tr_b16 a[246:247], v246 offset:30720
  s_waitcnt lgkmcnt(14)
  v_mfma_f32_32x32x16_bf16 v[144:159], a[224:227], v[96:99], v[144:159]
  ds_read_b64_tr_b16 a[248:249], v244 offset:32768
  ds_read_b64_tr_b16 a[250:251], v244 offset:34816
  v_add_f32 v222, v222, v212
  v_mfma_f32_32x32x16_bf16 v[160:175], a[228:231], v[96:99], v[160:175]
  ds_read_b64_tr_b16 a[252:253], v245 offset:32768
  ds_read_b64_tr_b16 a[254:255], v245 offset:34816
  s_waitcnt vmcnt(9)
  v_bitop3_b32 v10, v104, v108, v214 bitop3:0x96
  s_waitcnt lgkmcnt(10)
  v_mfma_f32_32x32x16_bf16 v[176:191], a[232:235], v[96:99], v[176:191]
  ds_read_b64_tr_b16 a[224:225], v246 offset:32768
  ds_read_b64_tr_b16 a[226:227], v246 offset:34816
  s_waitcnt vmcnt(8)
  v_xor_b32 v10, v10, v215
  v_mfma_f32_32x32x16_bf16 v[144:159], a[236:239], v[100:103], v[144:159]
  ds_read_b64_tr_b16 a[228:229], v244 offset:36864
  ds_read_b64_tr_b16 a[230:231], v244 offset:38912
  v_cmp_ne_u16 vcc, v10, v5
  s_waitcnt lgkmcnt(8)
  v_mfma_f32_32x32x16_bf16 v[160:175], a[240:243], v[100:103], v[160:175]
  ds_read_b64_tr_b16 a[232:233], v245 offset:36864
  ds_read_b64_tr_b16 a[234:235], v245 offset:38912
  s_add_u32 m0, s46, 0
  s_add_u32 s57, s42, 917504
  buffer_load_dwordx4 v136, s[28:31], s57 offen offset:0 lds
  s_cbranch_vccnz L_fh_r11
L_fh_ok11:
  v_mfma_f32_32x32x16_bf16 v[176:191], a[244:247], v[100:103], v[176:191]
  ds_read_b64_tr_b16 a[236:237], v246 offset:36864
  ds_read_b64_tr_b16 a[238:239], v246 offset:38912
  s_waitcnt lgkmcnt(8)
  v_mfma_f32_32x32x16_bf16 v[144:159], a[248:251], v[104:107], v[144:159]
  ds_read_b64_tr_b16 a[240:241], v244 offset:40960
  ds_read_b64_tr_b16 a[242:243], v244 offset:43008
  v_add_f32 v222, v222, v214
  v_mfma_f32_32x32x16_bf16 v[160:175], a[252:255], v[104:107], v[160:175]
  ds_read_b64_tr_b16 a[244:245], v245 offset:40960
  ds_read_b64_tr_b16 a[246:247], v245 offset:43008
  s_waitcnt vmcnt(6)
  v_bitop3_b32 v10, v112, v116, v216 bitop3:0x96
  buffer_load_dwordx4 v137, s[28:31], s57 offen offset:1024 lds
  s_waitcnt lgkmcnt(8)
  v_mfma_f32_32x32x16_bf16 v[176:191], a[224:227], v[104:107], v[176:191]
  ds_read_b64_tr_b16 a[248:249], v246 offset:40960
  ds_read_b64_tr_b16 a[250:251], v246 offset:43008
  s_waitcnt vmcnt(6)
  v_xor_b32 v10, v10, v217
  buffer_load_dwordx4 v128, s[28:31], s57 offen offset:2048 lds
  v_mfma_f32_32x32x16_bf16 v[144:159], a[228:231], v[108:111], v[144:159]
  ds_read_b64_tr_b16 a[252:253], v244 offset:45056
  ds_read_b64_tr_b16 a[254:255], v244 offset:47104
  v_cmp_ne_u16 vcc, v10, v5
  buffer_load_dwordx4 v129, s[28:31], s57 offen offset:3072 lds
  s_waitcnt lgkmcnt(8)
  v_mfma_f32_32x32x16_bf16 v[160:175], a[232:235], v[108:111], v[160:175]
  ds_read_b64_tr_b16 a[224:225], v245 offset:45056
  ds_read_b64_tr_b16 a[226:227], v245 offset:47104
  s_add_u32 m0, s46, 4096
  s_add_u32 s57, s42, 1146880
  buffer_load_dwordx4 v136, s[28:31], s57 offen offset:0 lds
  s_cbranch_vccnz L_fh_r12
L_fh_ok12:
  v_mfma_f32_32x32x16_bf16 v[176:191], a[236:239], v[108:111], v[176:191]
  ds_read_b64_tr_b16 a[228:229], v246 offset:45056
  ds_read_b64_tr_b16 a[230:231], v246 offset:47104
  s_waitcnt lgkmcnt(8)
  v_mfma_f32_32x32x16_bf16 v[144:159], a[240:243], v[112:115], v[144:159]
  ds_read_b64_tr_b16 a[232:233], v244 offset:49152
  ds_read_b64_tr_b16 a[234:235], v244 offset:51200
  v_add_f32 v222, v222, v216
  v_mfma_f32_32x32x16_bf16 v[160:175], a[244:247], v[112:115], v[160:175]
  ds_read_b64_tr_b16 a[236:237], v245 offset:49152
  ds_read_b64_tr_b16 a[238:239], v245 offset:51200
  s_waitcnt vmcnt(6)
  v_bitop3_b32 v10, v120, v124, v218 bitop3:0x96
  s_waitcnt lgkmcnt(8)
  v_mfma_f32_32x32x16_bf16 v[176:191], a[248:251], v[112:115], v[176:191]
  ds_read_b64_tr_b16 a[240:241], v246 offset:49152
  ds_read_b64_tr_b16 a[242:243], v246 offset:51200
  buffer_load_dwordx4 v137, s[28:31], s57 offen offset:1024 lds
  s_waitcnt vmcnt(6)
  v_xor_b32 v10, v10, v219
  v_mfma_f32_32x32x16_bf16 v[144:159], a[252:255], v[116:119], v[144:159]
  ds_read_b64_tr_b16 a[244:245], v244 offset:53248
  ds_read_b64_tr_b16 a[246:247], v244 offset:55296
  buffer_load_dwordx4 v128, s[28:31], s57 offen offset:2048 lds
  v_cmp_ne_u16 vcc, v10, v5
  s_waitcnt lgkmcnt(8)
  v_mfma_f32_32x32x16_bf16 v[160:175], a[224:227], v[116:119], v[160:175]
  ds_read_b64_tr_b16 a[248:249], v245 offset:53248
  ds_read_b64_tr_b16 a[250:251], v245 offset:55296
  buffer_load_dwordx4 v129, s[28:31], s57 offen offset:3072 lds
  s_cbranch_vccnz L_fh_r13
L_fh_ok13:
  v_mfma_f32_32x32x16_bf16 v[176:191], a[228:231], v[116:119], v[176:191]
  ds_read_b64_tr_b16 a[252:253], v246 offset:53248
  ds_read_b64_tr_b16 a[254:255], v246 offset:55296
  s_add_u32 m0, s46, 8192
  s_add_u32 s57, s42, 1376256
  buffer_load_dwordx4 v136, s[28:31], s57 offen offset:0 lds
  s_waitcnt lgkmcnt(8)
  v_mfma_f32_32x32x16_bf16 v[144:159], a[232:235], v[120:123], v[144:159]
  ds_read_b64_tr_b16 a[224:225], v243 offset:0
  ds_read_b64_tr_b16 a[226:227], v243 offset:2048
  v_add_f32 v222, v222, v218
  v_mfma_f32_32x32x16_bf16 v[160:175], a[236:239], v[120:123], v[160:175]
  ds_read_b64_tr_b16 a[228:229], v243 offset:4096
  ds_read_b64_tr_b16 a[230:231], v243 offset:6144
  v_mul_f32 v220, 0x3b124925, v222
  v_mov_b32 v221, v220
  s_nop 0
  s_nop 0
  v_permlane32_swap_b32 v220, v221
  s_waitcnt lgkmcnt(8)
  v_mfma_f32_32x32x16_bf16 v[176:191], a[240:243], v[120:123], v[176:191]
  ds_read_b64_tr_b16 a[232:233], v243 offset:8192
  ds_read_b64_tr_b16 a[234:235], v243 offset:10240
  v_fma_f32 v221, -v220, v220, v221
  v_max_f32 v221, 0, v221
  buffer_load_dwordx4 v137, s[28:31], s57 offen offset:1024 lds
  v_add_f32 v221, 0x3727c5ac, v221
  v_mfma_f32_32x32x16_bf16 v[144:159], a[244:247], v[124:127], v[144:159]
  ds_read_b64_tr_b16 a[236:237], v243 offset:12288
  ds_read_b64_tr_b16 a[238:239], v243 offset:14336
  v_rsq_f32 v251, v221
  v_cvt_pk_bf16_f32 v222, -v220, -v220
  buffer_load_dwordx4 v128, s[28:31], s57 offen offset:2048 lds
  s_waitcnt lgkmcnt(8)
  v_mfma_f32_32x32x16_bf16 v[160:175], a[248:251], v[124:127], v[160:175]
  ds_read_b64_tr_b16 a[240:241], v243 offset:16384
  ds_read_b64_tr_b16 a[242:243], v243 offset:18432
  v_lshlrev_b32 v9, 16, v222
  v_sub_f32 v9, -v220, v9
  v_cvt_pk_bf16_f32 v223, v9, 0
  v_mul_f32 v250, v221, v251
  buffer_load_dwordx4 v129, s[28:31], s57 offen offset:3072 lds
  v_mfma_f32_32x32x16_bf16 v[176:191], a[252:255], v[124:127], v[176:191]
  ds_read_b64_tr_b16 a[244:245], v243 offset:20480
  ds_read_b64_tr_b16 a[246:247], v243 offset:22528
  v_mul_f32 v251, 0xbfb8aa3b, v251
  v_cndmask_b32 v222, v222, 0, s[64:65]
  v_cndmask_b32 v223, v223, 0, s[64:65]
  s_nop 1
  v_mfma_f32_32x32x8_bf16 v[144:159], v[232:233], v[222:223], v[144:159]
  v_mfma_f32_32x32x8_bf16 v[160:175], v[234:235], v[222:223], v[160:175]
  v_mfma_f32_32x32x8_bf16 v[176:191], v[236:237], v[222:223], v[176:191]
  s_xor_b32 s50, s3, 0
  s_mul_i32 s50, s50, 2176
  s_add_u32 s50, s50, s63
  s_add_u32 s81, s43, 0
  buffer_load_dwordx4 a[112:115], v136, s[28:31], s81 offen offset:0
  s_nop 4
  v_pk_mul_f32 v[208:209], v[144:145], v[250:251] op_sel:[0,1] op_sel_hi:[1,1]
  v_pk_mul_f32 v[210:211], v[146:147], v[250:251] op_sel:[0,1] op_sel_hi:[1,1]
  v_pk_mul_f32 v[212:213], v[148:149], v[250:251] op_sel:[0,1] op_sel_hi:[1,1]
  v_pk_mul_f32 v[214:215], v[150:151], v[250:251] op_sel:[0,1] op_sel_hi:[1,1]
  v_exp_f32 v208, v208
  v_exp_f32 v209, v209
  v_exp_f32 v210, v210
  v_exp_f32 v211, v211
  v_exp_f32 v212, v212
  v_exp_f32 v213, v213
  v_exp_f32 v214, v214
  v_exp_f32 v215, v215
  buffer_load_dwordx4 a[116:119], v137, s[28:31], s81 offen offset:1024
  v_pk_fma_f32 v[208:209], v[208:209], v[250:251], v[250:251] op_sel_hi:[1,0,0]
  v_pk_fma_f32 v[210:211], v[210:211], v[250:251], v[250:251] op_sel_hi:[1,0,0]
  v_pk_fma_f32 v[212:213], v[212:213], v[250:251], v[250:251] op_sel_hi:[1,0,0]
  v_pk_fma_f32 v[214:215], v[214:215], v[250:251], v[250:251] op_sel_hi:[1,0,0]
  v_rcp_f32 v208, v208
  v_rcp_f32 v209, v209
  v_rcp_f32 v210, v210
  v_rcp_f32 v211, v211
  v_rcp_f32 v212, v212
  v_rcp_f32 v213, v213
  v_rcp_f32 v214, v214
  v_rcp_f32_e64 v215, v215
  buffer_load_dwordx4 a[120:123], v128, s[28:31], s81 offen offset:2048
  v_pk_mul_f32 v[144:145], v[144:145], v[208:209]
  v_pk_mul_f32 v[146:147], v[146:147], v[210:211]
  v_pk_mul_f32 v[148:149], v[148:149], v[212:213]
  v_pk_mul_f32 v[150:151], v[150:151], v[214:215]
  v_cvt_pk_bf16_f32 v144, v144, v145
  v_cvt_pk_bf16_f32 v145, v146, v147
  v_cvt_pk_bf16_f32 v146, v148, v149
  v_cvt_pk_bf16_f32 v147, v150, v151
  buffer_store_dwordx4 v[144:147], v2, s[36:39], s50 offen offset:0 sc1
  v_pk_mul_f32 v[208:209], v[152:153], v[250:251] op_sel:[0,1] op_sel_hi:[1,1]
  v_pk_mul_f32 v[210:211], v[154:155], v[250:251] op_sel:[0,1] op_sel_hi:[1,1]
  v_pk_mul_f32 v[212:213], v[156:157], v[250:251] op_sel:[0,1] op_sel_hi:[1,1]
  buffer_load_dwordx4 a[124:127], v129, s[28:31], s81 offen offset:3072
  v_pk_mul_f32 v[214:215], v[158:159], v[250:251] op_sel:[0,1] op_sel_hi:[1,1]
  v_exp_f32 v208, v208
  v_exp_f32 v209, v209
  v_exp_f32 v210, v210
  v_exp_f32 v211, v211
  v_exp_f32 v212, v212
  v_exp_f32 v213, v213
  v_exp_f32 v214, v214
  v_exp_f32 v215, v215
  v_pk_fma_f32 v[208:209], v[208:209], v[250:251], v[250:251] op_sel_hi:[1,0,0]
  v_pk_fma_f32 v[210:211], v[210:211], v[250:251], v[250:251] op_sel_hi:[1,0,0]
  v_pk_fma_f32 v[212:213], v[212:213], v[250:251], v[250:251] op_sel_hi:[1,0,0]
  s_add_u32 s81, s43, 229376
  buffer_load_dwordx4 a[128:131], v136, s[28:31], s81 offen offset:0
  v_pk_fma_f32 v[214:215], v[214:215], v[250:251], v[250:251] op_sel_hi:[1,0,0]
  v_rcp_f32 v208, v208
  v_rcp_f32 v209, v209
  v_rcp_f32 v210, v210
  v_rcp_f32 v211, v211
  v_rcp_f32 v212, v212
  v_rcp_f32 v213, v213
  v_rcp_f32 v214, v214
  v_rcp_f32 v215, v215
  v_pk_mul_f32 v[152:153], v[152:153], v[208:209]
  v_pk_mul_f32 v[154:155], v[154:155], v[210:211]
  v_pk_mul_f32 v[156:157], v[156:157], v[212:213]
  buffer_load_dwordx4 a[132:135], v137, s[28:31], s81 offen offset:1024
  v_pk_mul_f32 v[158:159], v[158:159], v[214:215]
  v_cvt_pk_bf16_f32 v152, v152, v153
  v_cvt_pk_bf16_f32 v153, v154, v155
  v_cvt_pk_bf16_f32 v154, v156, v157
  v_cvt_pk_bf16_f32 v155, v158, v159
  buffer_store_dwordx4 v[152:155], v2, s[36:39], s50 offen offset:1024 sc1
  v_bitop3_b32 v216, v5, v144, v152 bitop3:0x96
  buffer_store_short v216, v0, s[36:39], s50 offen offset:2048 sc1
  s_waitcnt lgkmcnt(8)
  v_mfma_f32_32x32x16_bf16 v[192:207], a[224:227], v[16:19], 0
  ds_read_b64_tr_b16 a[248:249], v243 offset:24576
  ds_read_b64_tr_b16 a[250:251], v243 offset:26624
  s_xor_b32 s50, s3, 1
  buffer_load_dwordx4 a[136:139], v128, s[28:31], s81 offen offset:2048
  s_mul_i32 s50, s50, 2176
  s_add_u32 s50, s50, s63
  v_mul_f32 v208, v160, v251
  v_mul_f32 v209, v161, v251
  v_mul_f32 v210, v162, v251
  v_mul_f32 v211, v163, v251
  v_mul_f32 v212, v164, v251
  v_mul_f32 v213, v165, v251
  v_mul_f32 v214, v166, v251
  v_mfma_f32_32x32x16_bf16 v[192:207], a[228:231], v[20:23], v[192:207]
  ds_read_b64_tr_b16 a[252:253], v243 offset:28672
  ds_read_b64_tr_b16 a[254:255], v243 offset:30720
  v_mul_f32 v215, v167, v251
  v_exp_f32 v208, v208
  v_exp_f32 v209, v209
  v_exp_f32 v210, v210
  buffer_load_dwordx4 a[140:143], v129, s[28:31], s81 offen offset:3072
  v_exp_f32 v211, v211
  v_exp_f32 v212, v212
  s_waitcnt lgkmcnt(8)
  v_mfma_f32_32x32x16_bf16 v[192:207], a[232:235], v[24:27], v[192:207]
  ds_read_b64_tr_b16 a[224:225], v243 offset:32768
  ds_read_b64_tr_b16 a[226:227], v243 offset:34816
  v_exp_f32 v213, v213
  v_exp_f32 v214, v214
  v_exp_f32 v215, v215
  v_fma_f32 v208, v208, v250, v250
  v_fma_f32 v209, v209, v250, v250
  v_fma_f32 v210, v210, v250, v250
  v_mfma_f32_32x32x16_bf16 v[192:207], a[236:239], v[28:31], v[192:207]
  ds_read_b64_tr_b16 a[228:229], v243 offset:36864
  ds_read_b64_tr_b16 a[230:231], v243 offset:38912
  v_fma_f32 v211, v211, v250, v250
  v_fma_f32 v212, v212, v250, v250
  v_fma_f32 v213, v213, v250, v250
  s_add_u32 s81, s43, 458752
  buffer_load_dwordx4 a[144:147], v136, s[28:31], s81 offen offset:0
  v_fma_f32 v214, v214, v250, v250
  v_fma_f32 v215, v215, v250, v250
  v_rcp_f32 v208, v208
  v_rcp_f32 v209, v209
  v_rcp_f32 v210, v210
  s_waitcnt lgkmcnt(8)
  v_mfma_f32_32x32x16_bf16 v[192:207], a[240:243], v[32:35], v[192:207]
  ds_read_b64_tr_b16 a[232:233], v243 offset:40960
  ds_read_b64_tr_b16 a[234:235], v243 offset:43008
  v_rcp_f32 v211, v211
  v_rcp_f32 v212, v212
  v_rcp_f32 v213, v213
  v_rcp_f32 v214, v214
  v_rcp_f32 v215, v215
  v_mfma_f32_32x32x16_bf16 v[192:207], a[244:247], v[36:39], v[192:207]
  ds_read_b64_tr_b16 a[236:237], v243 offset:45056
  ds_read_b64_tr_b16 a[238:239], v243 offset:47104
  v_mul_f32 v160, v160, v208
  v_mul_f32 v161, v161, v209
  v_mul_f32 v162, v162, v210
  v_mul_f32 v163, v163, v211
  v_mul_f32 v164, v164, v212
  v_mul_f32 v165, v165, v213
  v_mul_f32 v166, v166, v214
  v_mul_f32 v167, v167, v215
  s_waitcnt lgkmcnt(8)
  v_mfma_f32_32x32x16_bf16 v[192:207], a[248:251], v[40:43], v[192:207]
  ds_read_b64_tr_b16 a[240:241], v243 offset:49152
  ds_read_b64_tr_b16 a[242:243], v243 offset:51200
  v_cvt_pk_bf16_f32 v160, v160, v161
  v_cvt_pk_bf16_f32 v161, v162, v163
  v_cvt_pk_bf16_f32 v162, v164, v165
  v_cvt_pk_bf16_f32 v163, v166, v167
  buffer_store_dwordx4 v[160:163], v2, s[36:39], s50 offen offset:0 sc1
  v_mul_f32 v208, v168, v251
  v_mul_f32 v209, v169, v251
  buffer_load_dwordx4 a[148:151], v137, s[28:31], s81 offen offset:1024
  v_mul_f32 v210, v170, v251
  v_mul_f32 v211, v171, v251
  v_mul_f32 v212, v172, v251
  v_mfma_f32_32x32x16_bf16 v[192:207], a[252:255], v[44:47], v[192:207]
  ds_read_b64_tr_b16 a[244:245], v243 offset:53248
  ds_read_b64_tr_b16 a[246:247], v243 offset:55296
  v_mul_f32 v213, v173, v251
  v_mul_f32 v214, v174, v251
  v_mul_f32 v215, v175, v251
  v_exp_f32 v208, v208
  v_exp_f32 v209, v209
  v_exp_f32 v210, v210
  s_waitcnt lgkmcnt(8)
  v_mfma_f32_32x32x16_bf16 v[192:207], a[224:227], v[48:51], v[192:207]
  ds_read_b64_tr_b16 a[248:249], v247 offset:0
  ds_read_b64_tr_b16 a[250:251], v247 offset:2048
  v_exp_f32 v211, v211
  v_exp_f32 v212, v212
  buffer_load_dwordx4 a[152:155], v128, s[28:31], s81 offen offset:2048
  v_exp_f32 v213, v213
  v_exp_f32 v214, v214
  v_exp_f32 v215, v215
  v_fma_f32 v208, v208, v250, v250
  v_mfma_f32_32x32x16_bf16 v[192:207], a[228:231], v[52:55], v[192:207]
  s_nop 0
  ds_read_b64_tr_b16 a[252:253], v247 offset:4096
  ds_read_b64_tr_b16 a[254:255], v247 offset:6144
  v_fma_f32 v209, v209, v250, v250
  v_fma_f32 v210, v210, v250, v250
  v_fma_f32 v211, v211, v250, v250
  v_fma_f32 v212, v212, v250, v250
  v_fma_f32 v213, v213, v250, v250
  v_fma_f32 v214, v214, v250, v250
  v_fma_f32 v215, v215, v250, v250
  v_rcp_f32 v208, v208
  s_waitcnt lgkmcnt(8)
  v_mfma_f32_32x32x16_bf16 v[192:207], a[232:235], v[56:59], v[192:207]
  ds_read_b64_tr_b16 a[224:225], v247 offset:8192
  ds_read_b64_tr_b16 a[226:227], v247 offset:10240
  buffer_load_dwordx4 a[156:159], v129, s[28:31], s81 offen offset:3072
  v_rcp_f32 v209, v209
  v_rcp_f32 v210, v210
  v_rcp_f32 v211, v211
  v_rcp_f32 v212, v212
  v_rcp_f32 v213, v213
  v_rcp_f32 v214, v214
  v_mfma_f32_32x32x16_bf16 v[192:207], a[236:239], v[60:63], v[192:207]
  ds_read_b64_tr_b16 a[228:229], v247 offset:12288
  ds_read_b64_tr_b16 a[230:231], v247 offset:14336
  v_rcp_f32 v215, v215
  v_mul_f32 v168, v168, v208
  v_mul_f32 v169, v169, v209
  v_mul_f32 v170, v170, v210
  s_add_u32 s81, s43, 688128
  buffer_load_dwordx4 a[160:163], v136, s[28:31], s81 offen offset:0
  v_mul_f32 v171, v171, v211
  v_mul_f32 v172, v172, v212
  v_mul_f32 v173, v173, v213
  s_waitcnt lgkmcnt(8)
  v_mfma_f32_32x32x16_bf16 v[192:207], a[240:243], v[64:67], v[192:207]
  ds_read_b64_tr_b16 a[232:233], v247 offset:16384
  ds_read_b64_tr_b16 a[234:235], v247 offset:18432
  v_mul_f32 v174, v174, v214
  v_mul_f32 v175, v175, v215
  v_cvt_pk_bf16_f32 v168, v168, v169
  v_cvt_pk_bf16_f32 v169, v170, v171
  v_cvt_pk_bf16_f32 v170, v172, v173
  v_cvt_pk_bf16_f32 v171, v174, v175
  buffer_store_dwordx4 v[168:171], v2, s[36:39], s50 offen offset:1024 sc1
  v_bitop3_b32 v216, v5, v160, v168 bitop3:0x96
  buffer_store_short v216, v0, s[36:39], s50 offen offset:2048 sc1
  v_mfma_f32_32x32x16_bf16 v[192:207], a[244:247], v[68:71], v[192:207]
  ds_read_b64_tr_b16 a[236:237], v247 offset:20480
  ds_read_b64_tr_b16 a[238:239], v247 offset:22528
  s_xor_b32 s50, s3, 2
  s_mul_i32 s50, s50, 2176
  s_add_u32 s50, s50, s63
  v_mul_f32 v208, v176, v251
  v_mul_f32 v209, v177, v251
  v_mul_f32 v210, v178, v251
  v_mul_f32 v211, v179, v251
  v_mul_f32 v212, v180, v251
  v_mul_f32 v213, v181, v251
  v_mul_f32 v214, v182, v251
  s_waitcnt lgkmcnt(8)
  v_mfma_f32_32x32x16_bf16 v[192:207], a[248:251], v[72:75], v[192:207]
  ds_read_b64_tr_b16 a[240:241], v247 offset:24576
  ds_read_b64_tr_b16 a[242:243], v247 offset:26624
  v_mul_f32 v215, v183, v251
  v_exp_f32 v208, v208
  v_exp_f32 v209, v209
  v_exp_f32 v210, v210
  v_exp_f32 v211, v211
  v_exp_f32 v212, v212
  v_mfma_f32_32x32x16_bf16 v[192:207], a[252:255], v[76:79], v[192:207]
  ds_read_b64_tr_b16 a[244:245], v247 offset:28672
  ds_read_b64_tr_b16 a[246:247], v247 offset:30720
  buffer_load_dwordx4 a[164:167], v137, s[28:31], s81 offen offset:1024
  v_exp_f32 v213, v213
  v_exp_f32 v214, v214
  v_exp_f32 v215, v215
  v_fma_f32 v208, v208, v250, v250
  v_fma_f32 v209, v209, v250, v250
  v_fma_f32 v210, v210, v250, v250
  s_waitcnt lgkmcnt(8)
  v_mfma_f32_32x32x16_bf16 v[192:207], a[224:227], v[80:83], v[192:207]
  ds_read_b64_tr_b16 a[248:249], v247 offset:32768
  ds_read_b64_tr_b16 a[250:251], v247 offset:34816
  v_fma_f32 v211, v211, v250, v250
  v_fma_f32 v212, v212, v250, v250
  v_fma_f32 v213, v213, v250, v250
  v_fma_f32 v214, v214, v250, v250
  v_fma_f32 v215, v215, v250, v250
  v_rcp_f32 v208, v208
  buffer_load_dwordx4 a[168:171], v128, s[28:31], s81 offen offset:2048
  v_rcp_f32 v209, v209
  v_rcp_f32 v210, v210
  v_mfma_f32_32x32x16_bf16 v[192:207], a[228:231], v[84:87], v[192:207]
  ds_read_b64_tr_b16 a[252:253], v247 offset:36864
  ds_read_b64_tr_b16 a[254:255], v247 offset:38912
  v_rcp_f32 v211, v211
  v_rcp_f32 v212, v212
  v_rcp_f32 v213, v213
  v_rcp_f32 v214, v214
  v_rcp_f32 v215, v215
  s_waitcnt lgkmcnt(8)
  v_mfma_f32_32x32x16_bf16 v[192:207], a[232:235], v[88:91], v[192:207]
  ds_read_b64_tr_b16 a[224:225], v247 offset:40960
  ds_read_b64_tr_b16 a[226:227], v247 offset:43008
  v_mul_f32 v176, v176, v208
  v_mul_f32 v177, v177, v209
  buffer_load_dwordx4 a[172:175], v129, s[28:31], s81 offen offset:3072
  v_mul_f32 v178, v178, v210
  v_mul_f32 v179, v179, v211
  v_mul_f32 v180, v180, v212
  v_mul_f32 v181, v181, v213
  v_mul_f32 v182, v182, v214
  v_mul_f32 v183, v183, v215
  v_mfma_f32_32x32x16_bf16 v[192:207], a[236:239], v[92:95], v[192:207]
  s_nop 0
  ds_read_b64_tr_b16 a[228:229], v247 offset:45056
  ds_read_b64_tr_b16 a[230:231], v247 offset:47104
  v_cvt_pk_bf16_f32 v176, v176, v177
  v_cvt_pk_bf16_f32 v177, v178, v179
  v_cvt_pk_bf16_f32 v178, v180, v181
  v_cvt_pk_bf16_f32 v179, v182, v183
  buffer_store_dwordx4 v[176:179], v2, s[36:39], s50 offen offset:0 sc1
  v_mul_f32 v208, v184, v251
  v_mul_f32 v209, v185, v251
  v_mul_f32 v210, v186, v251
  v_mul_f32 v211, v187, v251
  v_mul_f32 v212, v188, v251
  s_waitcnt lgkmcnt(8)
  v_mfma_f32_32x32x16_bf16 v[192:207], a[240:243], v[96:99], v[192:207]
  ds_read_b64_tr_b16 a[232:233], v247 offset:49152
  ds_read_b64_tr_b16 a[234:235], v247 offset:51200
  s_add_u32 s56, s51, 0
  buffer_load_dwordx4 v[16:19], v2, s[36:39], s56 offen sc1
  v_mul_f32 v213, v189, v251
  v_mul_f32 v214, v190, v251
  v_mul_f32 v215, v191, v251
  v_exp_f32 v208, v208
  v_exp_f32 v209, v209
  v_exp_f32 v210, v210
  v_mfma_f32_32x32x16_bf16 v[192:207], a[244:247], v[100:103], v[192:207]
  ds_read_b64_tr_b16 a[236:237], v247 offset:53248
  ds_read_b64_tr_b16 a[238:239], v247 offset:55296
  v_exp_f32 v211, v211
  buffer_load_dwordx4 v[20:23], v2, s[36:39], s56 offen offset:1024 sc1
  v_exp_f32 v212, v212
  v_exp_f32 v213, v213
  buffer_load_ushort v240, v0, s[36:39], s56 offen offset:2048 sc1
  v_exp_f32 v214, v214
  v_exp_f32 v215, v215
  v_fma_f32 v208, v208, v250, v250
  s_waitcnt lgkmcnt(8)
  v_mfma_f32_32x32x16_bf16 v[192:207], a[248:251], v[104:107], v[192:207]
  s_nop 0
  s_add_u32 s56, s51, 17408
  buffer_load_dwordx4 v[24:27], v2, s[36:39], s56 offen sc1
  v_fma_f32 v209, v209, v250, v250
  v_fma_f32 v210, v210, v250, v250
  v_fma_f32 v211, v211, v250, v250
  v_fma_f32 v212, v212, v250, v250
  v_fma_f32 v213, v213, v250, v250
  v_fma_f32 v214, v214, v250, v250
  v_fma_f32 v215, v215, v250, v250
  v_rcp_f32 v208, v208
  v_mfma_f32_32x32x16_bf16 v[192:207], a[252:255], v[108:111], v[192:207]
  buffer_load_dwordx4 v[28:31], v2, s[36:39], s56 offen offset:1024 sc1
  v_rcp_f32 v209, v209
  v_rcp_f32 v210, v210
  v_rcp_f32 v211, v211
  buffer_load_ushort v241, v0, s[36:39], s56 offen offset:2048 sc1
  v_rcp_f32 v212, v212
  v_rcp_f32 v213, v213
  v_rcp_f32 v214, v214
  s_waitcnt lgkmcnt(4)
  v_mfma_f32_32x32x16_bf16 v[192:207], a[224:227], v[112:115], v[192:207]
  s_add_u32 s56, s51, 34816
  buffer_load_dwordx4 v[32:35], v2, s[36:39], s56 offen sc1
  v_rcp_f32 v215, v215
  v_mul_f32 v184, v184, v208
  v_mul_f32 v185, v185, v209
  v_mul_f32 v186, v186, v210
  v_mul_f32 v187, v187, v211
  v_mul_f32 v188, v188, v212
  v_mul_f32 v189, v189, v213
  v_mfma_f32_32x32x16_bf16 v[192:207], a[228:231], v[116:119], v[192:207]
  buffer_load_dwordx4 v[36:39], v2, s[36:39], s56 offen offset:1024 sc1
  v_mul_f32 v190, v190, v214
  v_mul_f32_e64 v191, v191, v215
  v_cvt_pk_bf16_f32 v184, v184, v185
  v_cvt_pk_bf16_f32 v185, v186, v187
  v_cvt_pk_bf16_f32 v186, v188, v189
  buffer_load_ushort v244, v0, s[36:39], s56 offen offset:2048 sc1
  v_cvt_pk_bf16_f32 v187, v190, v191
  buffer_store_dwordx4 v[184:187], v2, s[36:39], s50 offen offset:1024 sc1
  v_bitop3_b32 v216, v5, v176, v184 bitop3:0x96
  buffer_store_short v216, v0, s[36:39], s50 offen offset:2048 sc1
  s_waitcnt lgkmcnt(0)
  v_mfma_f32_32x32x16_bf16 v[192:207], a[232:235], v[120:123], v[192:207]
  s_add_u32 s56, s51, 52224
  buffer_load_dwordx4 v[40:43], v2, s[36:39], s56 offen sc1
  v_mfma_f32_32x32x16_bf16 v[192:207], a[236:239], v[124:127], v[192:207]
  buffer_load_dwordx4 v[44:47], v2, s[36:39], s56 offen offset:1024 sc1
  buffer_load_ushort v245, v0, s[36:39], s56 offen offset:2048 sc1
  v_mfma_f32_32x32x8_bf16 v[192:207], v[238:239], v[222:223], v[192:207]
  s_barrier
  s_waitcnt vmcnt(11)
  v_bitop3_b32 v10, v16, v20, v240 bitop3:0x96
  v_cmp_ne_u16 vcc, v10, v5
  s_cbranch_vccnz L_f4_r0
L_f4_ok0:
  v_mfma_f32_32x32x16_bf16 a[224:239], a[0:3], v[16:19], 0
  s_add_u32 s56, s51, 69632
  buffer_load_dwordx4 v[48:51], v2, s[36:39], s56 offen sc1
  ds_read_b64_tr_b16 a[64:65], v254 offset:0
  ds_read_b64_tr_b16 a[66:67], v254 offset:1024
  v_mfma_f32_32x32x16_bf16 a[240:255], a[4:7], v[16:19], 0
  s_xor_b32 s50, s3, 3
  s_mul_i32 s50, s50, 2176
  buffer_load_dwordx4 v[52:55], v2, s[36:39], s56 offen offset:1024 sc1
  buffer_load_ushort v248, v0, s[36:39], s56 offen offset:2048 sc1
  s_add_u32 s50, s50, s63
  v_mul_f32 v208, v192, v251
  v_mul_f32 v209, v193, v251
  ds_read_b64_tr_b16 a[68:69], v255 offset:0
  v_mul_f32 v210, v194, v251
  v_mul_f32 v211, v195, v251
  v_mul_f32 v212, v196, v251
  v_mfma_f32_32x32x16_bf16 a[224:239], a[8:11], v[20:23], a[224:239]
  s_waitcnt vmcnt(11)
  v_bitop3_b32 v10, v24, v28, v241 bitop3:0x96
  v_mul_f32 v213, v197, v251
  ds_read_b64_tr_b16 a[70:71], v255 offset:1024
  v_mul_f32 v214, v198, v251
  s_add_u32 s56, s51, 87040
  buffer_load_dwordx4 v[56:59], v2, s[36:39], s56 offen sc1
  v_mul_f32 v215, v199, v251
  v_exp_f32 v208, v208
  ds_read_b64_tr_b16 a[72:73], v254 offset:2048
  v_exp_f32 v209, v209
  v_cmp_ne_u16 vcc, v10, v5
  v_exp_f32 v210, v210
  v_mfma_f32_32x32x16_bf16 a[240:255], a[12:15], v[20:23], a[240:255]
  v_exp_f32 v211, v211
  ds_read_b64_tr_b16 a[74:75], v254 offset:3072
  buffer_load_dwordx4 v[60:63], v2, s[36:39], s56 offen offset:1024 sc1
  buffer_load_ushort v249, v0, s[36:39], s56 offen offset:2048 sc1
  v_exp_f32 v212, v212
  s_cbranch_vccnz L_f4_r1
L_f4_ok1:
  v_exp_f32 v213, v213
  ds_read_b64_tr_b16 a[76:77], v255 offset:2048
  v_exp_f32 v214, v214
  v_exp_f32 v215, v215
  v_mfma_f32_32x32x16_bf16 a[224:239], a[16:19], v[24:27], a[224:239]
  ds_read_b64_tr_b16 a[78:79], v255 offset:3072
  v_fma_f32 v208, v208, v250, v250
  s_add_u32 s56, s51, 104448
  buffer_load_dwordx4 v[64:67], v2, s[36:39], s56 offen sc1
  v_fma_f32 v209, v209, v250, v250
  v_fma_f32 v210, v210, v250, v250
  v_fma_f32 v211, v211, v250, v250
  v_fma_f32 v212, v212, v250, v250
  v_fma_f32 v213, v213, v250, v250
  v_fma_f32 v214, v214, v250, v250
  v_mfma_f32_32x32x16_bf16 a[240:255], a[20:23], v[24:27], a[240:255]
  v_fma_f32 v215, v215, v250, v250
  ds_read_b64_tr_b16 a[80:81], v254 offset:4096
  v_rcp_f32 v208, v208
  buffer_load_ushort v217, v0, s[36:39], s56 offen offset:2048 sc1
  v_rcp_f32 v209, v209
  v_rcp_f32 v210, v210
  ds_read_b64_tr_b16 a[82:83], v254 offset:5120
  v_rcp_f32 v211, v211
  v_mfma_f32_32x32x16_bf16 a[224:239], a[24:27], v[28:31], a[224:239]
  s_waitcnt vmcnt(13)
  v_bitop3_b32 v10, v32, v36, v244 bitop3:0x96
  v_rcp_f32 v212, v212
  ds_read_b64_tr_b16 a[84:85], v255 offset:4096
  buffer_load_dwordx4 v[68:71], v2, s[36:39], s56 offen offset:1024 sc1
  v_rcp_f32 v213, v213
  v_rcp_f32 v214, v214
  v_cmp_ne_u16 vcc, v10, v5
  ds_read_b64_tr_b16 a[86:87], v255 offset:5120
  v_rcp_f32 v215, v215
  v_mul_f32 v192, v192, v208
  v_mfma_f32_32x32x16_bf16 a[240:255], a[28:31], v[28:31], a[240:255]
  v_mul_f32 v193, v193, v209
  v_mul_f32 v194, v194, v210
  ds_read_b64_tr_b16 a[88:89], v254 offset:6144
  v_mul_f32 v195, v195, v211
  s_cbranch_vccnz L_f4_r2
L_f4_ok2:
  v_mul_f32 v196, v196, v212
  v_mul_f32 v197, v197, v213
  v_mul_f32 v198, v198, v214
  ds_read_b64_tr_b16 a[90:91], v254 offset:7168
  v_mul_f32 v199, v199, v215
  v_cvt_pk_bf16_f32 v192, v192, v193
  v_mfma_f32_32x32x16_bf16 a[224:239], a[32:35], v[32:35], a[224:239]
  v_cvt_pk_bf16_f32 v193, v194, v195
  v_cvt_pk_bf16_f32 v194, v196, v197
  s_add_u32 s56, s52, 0
  buffer_load_dwordx4 v[72:75], v2, s[36:39], s56 offen sc1
  ds_read_b64_tr_b16 a[92:93], v255 offset:6144
  v_cvt_pk_bf16_f32 v195, v198, v199
  buffer_store_dwordx4 v[192:195], v2, s[36:39], s50 offen offset:0 sc1
  v_mul_f32 v208, v200, v251
  v_mul_f32 v209, v201, v251
  ds_read_b64_tr_b16 a[94:95], v255 offset:7168
  v_mul_f32 v210, v202, v251
  v_mul_f32 v211, v203, v251
  v_mfma_f32_32x32x16_bf16 a[240:255], a[36:39], v[32:35], a[240:255]
  v_mul_f32 v212, v204, v251
  v_mul_f32 v213, v205, v251
  buffer_load_ushort v218, v0, s[36:39], s56 offen offset:2048 sc1
  v_mul_f32 v214, v206, v251
  v_mul_f32 v215, v207, v251
  v_exp_f32 v208, v208
  v_exp_f32 v209, v209
  ds_read_b64_tr_b16 a[96:97], v254 offset:8192
  v_mfma_f32_32x32x16_bf16 a[224:239], a[40:43], v[36:39], a[224:239]
  s_waitcnt vmcnt(12)
  v_bitop3_b32 v10, v40, v44, v245 bitop3:0x96
  v_exp_f32 v210, v210
  buffer_load_dwordx4 v[76:79], v2, s[36:39], s56 offen offset:1024 sc1
  v_exp_f32 v211, v211
  ds_read_b64_tr_b16 a[98:99], v254 offset:9216
  v_exp_f32 v212, v212
  v_cmp_ne_u16 vcc, v10, v5
  v_exp_f32 v213, v213
  ds_read_b64_tr_b16 a[100:101], v255 offset:8192
  v_exp_f32 v214, v214
  v_mfma_f32_32x32x16_bf16 a[240:255], a[44:47], v[36:39], a[240:255]
  v_exp_f32 v215, v215
  s_cbranch_vccnz L_f4_r3
L_f4_ok3:
  s_nop 0
  v_fma_f32 v208, v208, v250, v250
  ds_read_b64_tr_b16 a[102:103], v255 offset:9216
  v_fma_f32 v209, v209, v250, v250
  v_fma_f32 v210, v210, v250, v250
  v_fma_f32 v211, v211, v250, v250
  v_fma_f32 v212, v212, v250, v250
  ds_read_b64_tr_b16 a[104:105], v254 offset:10240
  v_fma_f32 v213, v213, v250, v250
  v_mfma_f32_32x32x16_bf16 a[224:239], a[48:51], v[40:43], a[224:239]
  v_fma_f32 v214, v214, v250, v250
  s_add_u32 s56, s52, 17408
  buffer_load_dwordx4 v[80:83], v2, s[36:39], s56 offen sc1
  v_fma_f32 v215, v215, v250, v250
  v_rcp_f32 v208, v208
  ds_read_b64_tr_b16 a[106:107], v254 offset:11264
  v_rcp_f32 v209, v209
  v_rcp_f32 v210, v210
  ds_read_b64_tr_b16 a[108:109], v255 offset:10240
  v_mfma_f32_32x32x16_bf16 a[240:255], a[52:55], v[40:43], a[240:255]
  v_rcp_f32 v211, v211
  buffer_load_ushort v219, v0, s[36:39], s56 offen offset:2048 sc1
  v_rcp_f32 v212, v212
  v_rcp_f32 v213, v213
  ds_read_b64_tr_b16 a[110:111], v255 offset:11264
  v_rcp_f32 v214, v214
  v_rcp_f32 v215, v215
  v_mfma_f32_32x32x16_bf16 a[224:239], a[56:59], v[44:47], a[224:239]
  s_waitcnt vmcnt(12)
  v_bitop3_b32 v10, v48, v52, v248 bitop3:0x96
  v_mul_f32 v200, v200, v208
  buffer_load_dwordx4 v[84:87], v2, s[36:39], s56 offen offset:1024 sc1
  v_mul_f32 v201, v201, v209
  v_mul_f32 v202, v202, v210
  v_mul_f32 v203, v203, v211
  v_mul_f32 v204, v204, v212
  v_cmp_ne_u16 vcc, v10, v5
  v_mul_f32 v205, v205, v213
  v_mul_f32 v206, v206, v214
  v_mul_f32 v207, v207, v215
  v_mfma_f32_32x32x16_bf16 a[240:255], a[60:63], v[44:47], a[240:255]
  v_cvt_pk_bf16_f32 v200, v200, v201
  v_cvt_pk_bf16_f32 v201, v202, v203
  s_cbranch_vccnz L_f4_r4
L_f4_ok4:
  v_cvt_pk_bf16_f32 v202, v204, v205
  v_cvt_pk_bf16_f32 v203, v206, v207
  buffer_store_dwordx4 v[200:203], v2, s[36:39], s50 offen offset:1024 sc1
  v_bitop3_b32 v216, v5, v192, v200 bitop3:0x96
  buffer_store_short v216, v0, s[36:39], s50 offen offset:2048 sc1
  s_waitcnt lgkmcnt(15)
  v_mfma_f32_32x32x16_bf16 a[224:239], a[64:67], v[48:51], a[224:239]
  s_add_u32 s56, s52, 34816
  buffer_load_dwordx4 v[88:91], v2, s[36:39], s56 offen sc1
  v_mfma_f32_32x32x16_bf16 a[240:255], a[68:71], v[48:51], a[240:255]
  buffer_load_ushort v130, v0, s[36:39], s56 offen offset:2048 sc1
  v_mfma_f32_32x32x16_bf16 a[224:239], a[72:75], v[52:55], a[224:239]
  s_waitcnt vmcnt(14)
  v_bitop3_b32 v10, v56, v60, v249 bitop3:0x96
  buffer_load_dwordx4 v[92:95], v2, s[36:39], s56 offen offset:1024 sc1
  v_cmp_ne_u16 vcc, v10, v5
  v_mfma_f32_32x32x16_bf16 a[240:255], a[76:79], v[52:55], a[240:255]
  s_cbranch_vccnz L_f4_r5
L_f4_ok5:
  s_waitcnt lgkmcnt(14)
  v_mfma_f32_32x32x16_bf16 a[224:239], a[80:83], v[56:59], a[224:239]
  s_add_u32 m0, s47, 16384
  s_add_u32 s57, s43, 917504
  buffer_load_dwordx4 v136, s[28:31], s57 offen offset:0 lds
  s_add_u32 s56, s52, 52224
  buffer_load_dwordx4 v[96:99], v2, s[36:39], s56 offen sc1
  s_waitcnt lgkmcnt(12)
  v_mfma_f32_32x32x16_bf16 a[240:255], a[84:87], v[56:59], a[240:255]
  buffer_load_ushort v242, v0, s[36:39], s56 offen offset:2048 sc1
  s_waitcnt lgkmcnt(10)
  v_mfma_f32_32x32x16_bf16 a[224:239], a[88:91], v[60:63], a[224:239]
  s_waitcnt vmcnt(15)
  v_bitop3_b32 v10, v64, v68, v217 bitop3:0x96
  v_lshlrev_b32 v144, 16, v224
  buffer_load_dwordx4 v[100:103], v2, s[36:39], s56 offen offset:1024 sc1
  v_and_b32 v145, s55, v224
  v_lshlrev_b32 v146, 16, v225
  v_cmp_ne_u16 vcc, v10, v5
  v_and_b32 v147, s55, v225
  s_waitcnt lgkmcnt(8)
  v_mfma_f32_32x32x16_bf16 a[240:255], a[92:95], v[60:63], a[240:255]
  v_lshlrev_b32 v148, 16, v226
  s_cbranch_vccnz L_f4_r6
L_f4_ok6:
  v_and_b32 v149, s55, v226
  v_lshlrev_b32 v150, 16, v227
  s_waitcnt lgkmcnt(6)
  v_mfma_f32_32x32x16_bf16 a[224:239], a[96:99], v[64:67], a[224:239]
  v_and_b32 v151, s55, v227
  s_add_u32 s56, s52, 69632
  buffer_load_dwordx4 v[104:107], v2, s[36:39], s56 offen sc1
  buffer_load_dwordx4 v137, s[28:31], s57 offen offset:1024 lds
  v_lshlrev_b32 v152, 16, v228
  v_and_b32 v153, s55, v228
  s_waitcnt lgkmcnt(4)
  v_mfma_f32_32x32x16_bf16 a[240:255], a[100:103], v[64:67], a[240:255]
  v_lshlrev_b32 v154, 16, v229
  buffer_load_ushort v246, v0, s[36:39], s56 offen offset:2048 sc1
  v_and_b32 v155, s55, v229
  v_lshlrev_b32 v156, 16, v230
  buffer_load_dwordx4 v128, s[28:31], s57 offen offset:2048 lds
  s_waitcnt lgkmcnt(2)
  v_mfma_f32_32x32x16_bf16 a[224:239], a[104:107], v[68:71], a[224:239]
  s_waitcnt vmcnt(16)
  v_bitop3_b32 v10, v72, v76, v218 bitop3:0x96
  v_and_b32 v157, s55, v230
  buffer_load_dwordx4 v[108:111], v2, s[36:39], s56 offen offset:1024 sc1
  v_lshlrev_b32 v158, 16, v231
  v_cmp_ne_u16 vcc, v10, v5
  v_and_b32 v159, s55, v231
  s_waitcnt lgkmcnt(0)
  v_mfma_f32_32x32x16_bf16 a[240:255], a[108:111], v[68:71], a[240:255]
  buffer_load_dwordx4 v129, s[28:31], s57 offen offset:3072 lds
  s_cbranch_vccnz L_f4_r7
L_f4_ok7:
  v_mfma_f32_32x32x16_bf16 v[144:159], a[0:3], v[72:75], v[144:159]
  s_add_u32 s56, s52, 87040
  buffer_load_dwordx4 v[112:115], v2, s[36:39], s56 offen sc1
  s_add_u32 m0, s47, 20480
  s_add_u32 s57, s43, 1146880
  buffer_load_dwordx4 v136, s[28:31], s57 offen offset:0 lds
  v_mfma_f32_32x32x16_bf16 v[160:175], a[4:7], v[72:75], 0
  buffer_load_ushort v243, v0, s[36:39], s56 offen offset:2048 sc1
  v_mfma_f32_32x32x16_bf16 v[144:159], a[8:11], v[76:79], v[144:159]
  s_waitcnt vmcnt(18)
  v_bitop3_b32 v10, v80, v84, v219 bitop3:0x96
  buffer_load_dwordx4 v[116:119], v2, s[36:39], s56 offen offset:1024 sc1
  v_cmp_ne_u16 vcc, v10, v5
  v_mfma_f32_32x32x16_bf16 v[160:175], a[12:15], v[76:79], v[160:175]
  s_cbranch_vccnz L_f4_r8
L_f4_ok8:
  v_mfma_f32_32x32x16_bf16 v[144:159], a[16:19], v[80:83], v[144:159]
  s_add_u32 s56, s52, 104448
  buffer_load_dwordx4 v[120:123], v2, s[36:39], s56 offen sc1
  v_mfma_f32_32x32x16_bf16 v[160:175], a[20:23], v[80:83], v[160:175]
  buffer_load_dwordx4 v137, s[28:31], s57 offen offset:1024 lds
  buffer_load_ushort v247, v0, s[36:39], s56 offen offset:2048 sc1
  v_mfma_f32_32x32x16_bf16 v[144:159], a[24:27], v[84:87], v[144:159]
  s_waitcnt vmcnt(17)
  v_bitop3_b32 v10, v88, v92, v130 bitop3:0x96
  buffer_load_dwordx4 v[124:127], v2, s[36:39], s56 offen offset:1024 sc1
  buffer_load_dwordx4 v128, s[28:31], s57 offen offset:2048 lds
  v_cmp_ne_u16 vcc, v10, v5
  v_mfma_f32_32x32x16_bf16 v[160:175], a[28:31], v[84:87], v[160:175]
  s_cbranch_vccnz L_f4_r9
L_f4_ok9:
  buffer_load_dwordx4 v129, s[28:31], s57 offen offset:3072 lds
  v_mfma_f32_32x32x16_bf16 v[144:159], a[32:35], v[88:91], v[144:159]
  s_add_u32 s56, s53, 0
  buffer_load_dwordx4 v[16:19], v2, s[36:39], s56 offen sc1
  v_mfma_f32_32x32x16_bf16 v[160:175], a[36:39], v[88:91], v[160:175]
  buffer_load_ushort v240, v0, s[36:39], s56 offen offset:2048 sc1
  s_add_u32 m0, s47, 24576
  s_add_u32 s57, s43, 1376256
  buffer_load_dwordx4 v136, s[28:31], s57 offen offset:0 lds
  v_mfma_f32_32x32x16_bf16 v[144:159], a[40:43], v[92:95], v[144:159]
  s_waitcnt vmcnt(19)
  v_bitop3_b32 v10, v96, v100, v242 bitop3:0x96
  buffer_load_dwordx4 v[20:23], v2, s[36:39], s56 offen offset:1024 sc1
  v_cmp_ne_u16 vcc, v10, v5
  v_mfma_f32_32x32x16_bf16 v[160:175], a[44:47], v[92:95], v[160:175]
  s_cbranch_vccnz L_f4_r10
L_f4_ok10:
  v_mfma_f32_32x32x16_bf16 v[144:159], a[48:51], v[96:99], v[144:159]
  s_add_u32 s56, s53, 17408
  buffer_load_dwordx4 v[24:27], v2, s[36:39], s56 offen sc1
  v_mfma_f32_32x32x16_bf16 v[160:175], a[52:55], v[96:99], v[160:175]
  buffer_load_ushort v241, v0, s[36:39], s56 offen offset:2048 sc1
  buffer_load_dwordx4 v137, s[28:31], s57 offen offset:1024 lds
  v_mfma_f32_32x32x16_bf16 v[144:159], a[56:59], v[100:103], v[144:159]
  s_waitcnt vmcnt(18)
  v_bitop3_b32 v10, v104, v108, v246 bitop3:0x96
  buffer_load_dwordx4 v[28:31], v2, s[36:39], s56 offen offset:1024 sc1
  v_cmp_ne_u16 vcc, v10, v5
  v_mfma_f32_32x32x16_bf16 v[160:175], a[60:63], v[100:103], v[160:175]
  buffer_load_dwordx4 v128, s[28:31], s57 offen offset:2048 lds
  s_cbranch_vccnz L_f4_r11
L_f4_ok11:
  v_mfma_f32_32x32x16_bf16 v[144:159], a[64:67], v[104:107], v[144:159]
  ds_write_b128 v131, a[112:115] offset:0
  s_add_u32 s56, s53, 34816
  buffer_load_dwordx4 v[32:35], v2, s[36:39], s56 offen sc1
  buffer_load_dwordx4 v129, s[28:31], s57 offen offset:3072 lds
  ds_write_b128 v131, a[116:119] offset:1024
  v_mfma_f32_32x32x16_bf16 v[160:175], a[68:71], v[104:107], v[160:175]
  buffer_load_ushort v244, v0, s[36:39], s56 offen offset:2048 sc1
  ds_write_b128 v131, a[120:123] offset:2048
  v_mfma_f32_32x32x16_bf16 v[144:159], a[72:75], v[108:111], v[144:159]
  s_waitcnt vmcnt(18)
  v_bitop3_b32 v10, v112, v116, v243 bitop3:0x96
  buffer_load_dwordx4 v[36:39], v2, s[36:39], s56 offen offset:1024 sc1
  v_cmp_ne_u16 vcc, v10, v5
  ds_write_b128 v131, a[124:127] offset:3072
  v_mfma_f32_32x32x16_bf16 v[160:175], a[76:79], v[108:111], v[160:175]
  s_cbranch_vccnz L_f4_r12
L_f4_ok12:
  ds_read_b64_tr_b16 a[112:113], v252 offset:0
  ds_read_b64_tr_b16 a[114:115], v252 offset:1024
  v_mfma_f32_32x32x16_bf16 v[144:159], a[80:83], v[112:115], v[144:159]
  s_nop 0
  ds_read_b64_tr_b16 a[116:117], v253 offset:0
  s_add_u32 s56, s53, 52224
  buffer_load_dwordx4 v[40:43], v2, s[36:39], s56 offen sc1
  ds_read_b64_tr_b16 a[118:119], v253 offset:1024
  ds_read_b64_tr_b16 a[120:121], v252 offset:2048
  ds_read_b64_tr_b16 a[122:123], v252 offset:3072
  ds_read_b64_tr_b16 a[124:125], v253 offset:2048
  ds_read_b64_tr_b16 a[126:127], v253 offset:3072
  v_mfma_f32_32x32x16_bf16 v[160:175], a[84:87], v[112:115], v[160:175]
  ds_write_b128 v131, a[128:131] offset:4096
  buffer_load_ushort v245, v0, s[36:39], s56 offen offset:2048 sc1
  ds_write_b128 v131, a[132:135] offset:5120
  v_mfma_f32_32x32x16_bf16 v[144:159], a[88:91], v[116:119], v[144:159]
  s_waitcnt vmcnt(17)
  v_bitop3_b32 v10, v120, v124, v247 bitop3:0x96
  buffer_load_dwordx4 v[44:47], v2, s[36:39], s56 offen offset:1024 sc1
  v_cmp_ne_u16 vcc, v10, v5
  ds_write_b128 v131, a[136:139] offset:6144
  v_mfma_f32_32x32x16_bf16 v[160:175], a[92:95], v[116:119], v[160:175]
  s_cbranch_vccnz L_f4_r13
L_f4_ok13:
  ds_write_b128 v131, a[140:143] offset:7168
  v_mfma_f32_32x32x16_bf16 v[144:159], a[96:99], v[120:123], v[144:159]
  s_add_u32 s56, s53, 69632
  buffer_load_dwordx4 v[48:51], v2, s[36:39], s56 offen sc1
  ds_read_b64_tr_b16 a[128:129], v252 offset:4096
  ds_read_b64_tr_b16 a[130:131], v252 offset:5120
  v_mfma_f32_32x32x16_bf16 v[160:175], a[100:103], v[120:123], v[160:175]
  s_nop 0
  ds_read_b64_tr_b16 a[132:133], v253 offset:4096
  buffer_load_ushort v248, v0, s[36:39], s56 offen offset:2048 sc1
  ds_read_b64_tr_b16 a[134:135], v253 offset:5120
  ds_read_b64_tr_b16 a[136:137], v252 offset:6144
  ds_read_b64_tr_b16 a[138:139], v252 offset:7168
  ds_read_b64_tr_b16 a[140:141], v253 offset:6144
  ds_read_b64_tr_b16 a[142:143], v253 offset:7168
  v_mfma_f32_32x32x16_bf16 v[144:159], a[104:107], v[124:127], v[144:159]
  s_waitcnt vmcnt(14)
  v_bitop3_b32 v10, v16, v20, v240 bitop3:0x96
  ds_write_b128 v131, a[144:147] offset:8192
  buffer_load_dwordx4 v[52:55], v2, s[36:39], s56 offen offset:1024 sc1
  v_cmp_ne_u16 vcc, v10, v5
  ds_write_b128 v131, a[148:151] offset:9216
  v_mfma_f32_32x32x16_bf16 v[160:175], a[108:111], v[124:127], v[160:175]
  s_cbranch_vccnz L_f4_r14
L_f4_ok14:
  ds_write_b128 v131, a[152:155] offset:10240
  s_waitcnt lgkmcnt(15)
  v_mfma_f32_32x32x16_bf16 a[224:239], a[112:115], v[16:19], a[224:239]
  s_add_u32 s56, s53, 87040
  buffer_load_dwordx4 v[56:59], v2, s[36:39], s56 offen sc1
  ds_write_b128 v131, a[156:159] offset:11264
  v_mfma_f32_32x32x16_bf16 a[240:255], a[116:119], v[16:19], a[240:255]
  buffer_load_ushort v249, v0, s[36:39], s56 offen offset:2048 sc1
  ds_read_b64_tr_b16 a[144:145], v252 offset:8192
  ds_read_b64_tr_b16 a[146:147], v252 offset:9216
  v_mfma_f32_32x32x16_bf16 a[224:239], a[120:123], v[20:23], a[224:239]
  s_waitcnt vmcnt(13)
  s_nop 0
  v_bitop3_b32 v10, v24, v28, v241 bitop3:0x96
  ds_read_b64_tr_b16 a[148:149], v253 offset:8192
  buffer_load_dwordx4 v[60:63], v2, s[36:39], s56 offen offset:1024 sc1
  ds_read_b64_tr_b16 a[150:151], v253 offset:9216
  ds_read_b64_tr_b16 a[152:153], v252 offset:10240
  ds_read_b64_tr_b16 a[154:155], v252 offset:11264
  v_cmp_ne_u16 vcc, v10, v5
  ds_read_b64_tr_b16 a[156:157], v253 offset:10240
  ds_read_b64_tr_b16 a[158:159], v253 offset:11264
  v_mfma_f32_32x32x16_bf16 a[240:255], a[124:127], v[20:23], a[240:255]
  ds_write_b128 v131, a[160:163] offset:12288
  s_cbranch_vccnz L_f4_r15
L_f4_ok15:
  ds_write_b128 v131, a[164:167] offset:13312
  s_waitcnt lgkmcnt(15)
  v_mfma_f32_32x32x16_bf16 a[224:239], a[128:131], v[24:27], a[224:239]
  s_add_u32 s56, s53, 104448
  buffer_load_dwordx4 v[64:67], v2, s[36:39], s56 offen sc1
  ds_write_b128 v131, a[168:171] offset:14336
  v_mfma_f32_32x32x16_bf16 a[240:255], a[132:135], v[24:27], a[240:255]
  buffer_load_ushort v217, v0, s[36:39], s56 offen offset:2048 sc1
  ds_write_b128 v131, a[172:175] offset:15360
  v_mfma_f32_32x32x16_bf16 a[224:239], a[136:139], v[28:31], a[224:239]
  s_waitcnt vmcnt(11)
  v_bitop3_b32 v10, v32, v36, v244 bitop3:0x96
  buffer_load_dwordx4 v[68:71], v2, s[36:39], s56 offen offset:1024 sc1
  v_cmp_ne_u16 vcc, v10, v5
  ds_read_b64_tr_b16 a[160:161], v252 offset:12288
  ds_read_b64_tr_b16 a[162:163], v252 offset:13312
  s_waitcnt lgkmcnt(15)
  v_mfma_f32_32x32x16_bf16 a[240:255], a[140:143], v[28:31], a[240:255]
  ds_read_b64_tr_b16 a[164:165], v253 offset:12288
  ds_read_b64_tr_b16 a[166:167], v253 offset:13312
  s_cbranch_vccnz L_f4_r16
L_f4_ok16:
  ds_read_b64_tr_b16 a[168:169], v252 offset:14336
  ds_read_b64_tr_b16 a[170:171], v252 offset:15360
  ds_read_b64_tr_b16 a[172:173], v253 offset:14336
  ds_read_b64_tr_b16 a[174:175], v253 offset:15360
  s_waitcnt lgkmcnt(15)
  v_mfma_f32_32x32x16_bf16 a[224:239], a[144:147], v[32:35], a[224:239]
  s_add_u32 s56, s54, 0
  buffer_load_dwordx4 v[72:75], v2, s[36:39], s56 offen sc1
  ds_read_b64_tr_b16 a[176:177], v252 offset:16384
  v_mfma_f32_32x32x16_bf16 a[240:255], a[148:151], v[32:35], a[240:255]
  ds_read_b64_tr_b16 a[178:179], v252 offset:17408
  buffer_load_ushort v218, v0, s[36:39], s56 offen offset:2048 sc1
  ds_read_b64_tr_b16 a[180:181], v253 offset:16384
  s_waitcnt lgkmcnt(15)
  v_mfma_f32_32x32x16_bf16 a[224:239], a[152:155], v[36:39], a[224:239]
  s_waitcnt vmcnt(11)
  v_bitop3_b32 v10, v40, v44, v245 bitop3:0x96
  ds_read_b64_tr_b16 a[182:183], v253 offset:17408
  buffer_load_dwordx4 v[76:79], v2, s[36:39], s56 offen offset:1024 sc1
  v_cmp_ne_u16 vcc, v10, v5
  ds_read_b64_tr_b16 a[184:185], v252 offset:18432
  v_mfma_f32_32x32x16_bf16 a[240:255], a[156:159], v[36:39], a[240:255]
  ds_read_b64_tr_b16 a[186:187], v252 offset:19456
  s_cbranch_vccnz L_f4_r17
L_f4_ok17:
  ds_read_b64_tr_b16 a[188:189], v253 offset:18432
  s_waitcnt lgkmcnt(13)
  v_mfma_f32_32x32x16_bf16 a[224:239], a[160:163], v[40:43], a[224:239]
  s_add_u32 s56, s54, 17408
  buffer_load_dwordx4 v[80:83], v2, s[36:39], s56 offen sc1
  ds_read_b64_tr_b16 a[190:191], v253 offset:19456
  s_waitcnt lgkmcnt(12)
  v_mfma_f32_32x32x16_bf16 a[240:255], a[164:167], v[40:43], a[240:255]
  buffer_load_ushort v219, v0, s[36:39], s56 offen offset:2048 sc1
  ds_read_b64_tr_b16 a[192:193], v252 offset:20480
  s_waitcnt lgkmcnt(11)
  v_mfma_f32_32x32x16_bf16 a[224:239], a[168:171], v[44:47], a[224:239]
  s_waitcnt vmcnt(11)
  v_bitop3_b32 v10, v48, v52, v248 bitop3:0x96
  ds_read_b64_tr_b16 a[194:195], v252 offset:21504
  buffer_load_dwordx4 v[84:87], v2, s[36:39], s56 offen offset:1024 sc1
  ds_read_b64_tr_b16 a[196:197], v253 offset:20480
  v_cmp_ne_u16 vcc, v10, v5
  s_waitcnt lgkmcnt(11)
  v_mfma_f32_32x32x16_bf16 a[240:255], a[172:175], v[44:47], a[240:255]
  ds_read_b64_tr_b16 a[198:199], v253 offset:21504
  s_cbranch_vccnz L_f4_r18
L_f4_ok18:
  ds_read_b64_tr_b16 a[200:201], v252 offset:22528
  s_waitcnt lgkmcnt(11)
  v_mfma_f32_32x32x16_bf16 a[224:239], a[176:179], v[48:51], a[224:239]
  s_add_u32 s56, s54, 34816
  buffer_load_dwordx4 v[88:91], v2, s[36:39], s56 offen sc1
  ds_read_b64_tr_b16 a[202:203], v252 offset:23552
  ds_read_b64_tr_b16 a[204:205], v253 offset:22528
  s_waitcnt lgkmcnt(11)
  v_mfma_f32_32x32x16_bf16 a[240:255], a[180:183], v[48:51], a[240:255]
  buffer_load_ushort v130, v0, s[36:39], s56 offen offset:2048 sc1
  ds_read_b64_tr_b16 a[206:207], v253 offset:23552
  s_waitcnt lgkmcnt(10)
  v_mfma_f32_32x32x16_bf16 a[224:239], a[184:187], v[52:55], a[224:239]
  s_waitcnt vmcnt(11)
  v_bitop3_b32 v10, v56, v60, v249 bitop3:0x96
  buffer_load_dwordx4 v[92:95], v2, s[36:39], s56 offen offset:1024 sc1
  ds_read_b64_tr_b16 a[208:209], v252 offset:24576
  v_cmp_ne_u16 vcc, v10, v5
  s_waitcnt lgkmcnt(9)
  v_mfma_f32_32x32x16_bf16 a[240:255], a[188:191], v[52:55], a[240:255]
  ds_read_b64_tr_b16 a[210:211], v252 offset:25600
  s_cbranch_vccnz L_f4_r19
L_f4_ok19:
  ds_read_b64_tr_b16 a[212:213], v253 offset:24576
  s_waitcnt lgkmcnt(9)
  v_mfma_f32_32x32x16_bf16 a[224:239], a[192:195], v[56:59], a[224:239]
  ds_read_b64_tr_b16 a[214:215], v253 offset:25600
  s_add_u32 s56, s54, 52224
  buffer_load_dwordx4 v[96:99], v2, s[36:39], s56 offen sc1
  ds_read_b64_tr_b16 a[216:217], v252 offset:26624
  s_waitcnt lgkmcnt(9)
  v_mfma_f32_32x32x16_bf16 a[240:255], a[196:199], v[56:59], a[240:255]
  buffer_load_ushort v242, v0, s[36:39], s56 offen offset:2048 sc1
  ds_read_b64_tr_b16 a[218:219], v252 offset:27648
  ds_read_b64_tr_b16 a[220:221], v253 offset:26624
  s_waitcnt lgkmcnt(9)
  v_mfma_f32_32x32x16_bf16 a[224:239], a[200:203], v[60:63], a[224:239]
  s_waitcnt vmcnt(11)
  v_bitop3_b32 v10, v64, v68, v217 bitop3:0x96
  buffer_load_dwordx4 v[100:103], v2, s[36:39], s56 offen offset:1024 sc1
  ds_read_b64_tr_b16 a[222:223], v253 offset:27648
  v_cmp_ne_u16 vcc, v10, v5
  s_waitcnt lgkmcnt(8)
  v_mfma_f32_32x32x16_bf16 a[240:255], a[204:207], v[60:63], a[240:255]
  s_cbranch_vccnz L_f4_r20
L_f4_ok20:
  s_waitcnt lgkmcnt(6)
  v_mfma_f32_32x32x16_bf16 a[224:239], a[208:211], v[64:67], a[224:239]
  s_add_u32 s56, s54, 69632
  buffer_load_dwordx4 v[104:107], v2, s[36:39], s56 offen sc1
  s_waitcnt lgkmcnt(4)
  v_mfma_f32_32x32x16_bf16 a[240:255], a[212:215], v[64:67], a[240:255]
  buffer_load_ushort v246, v0, s[36:39], s56 offen offset:2048 sc1
  s_waitcnt lgkmcnt(2)
  v_mfma_f32_32x32x16_bf16 a[224:239], a[216:219], v[68:71], a[224:239]
  s_waitcnt vmcnt(11)
  v_bitop3_b32 v10, v72, v76, v218 bitop3:0x96
  buffer_load_dwordx4 v[108:111], v2, s[36:39], s56 offen offset:1024 sc1
  s_lshl_b32 s70, s3, 14
  v_add_u32 v13, s70, v2
  v_xor_b32 v9, 16384, v13
  v_xor_b32 v12, 32768, v13
  v_xor_b32 v14, 49152, v13
  s_waitcnt lgkmcnt(0)
  s_barrier
  v_cmp_ne_u16 vcc, v10, v5
  v_mfma_f32_32x32x16_bf16 a[240:255], a[220:223], v[68:71], a[240:255]
  s_cbranch_vccnz L_f4_r21
L_f4_ok21:
  v_mfma_f32_32x32x16_bf16 v[144:159], a[112:115], v[72:75], v[144:159]
  s_add_u32 s56, s54, 87040
  buffer_load_dwordx4 v[112:115], v2, s[36:39], s56 offen sc1
  v_mfma_f32_32x32x16_bf16 v[160:175], a[116:119], v[72:75], v[160:175]
  buffer_load_ushort v243, v0, s[36:39], s56 offen offset:2048 sc1
  v_mfma_f32_32x32x16_bf16 v[144:159], a[120:123], v[76:79], v[144:159]
  s_waitcnt vmcnt(11)
  v_bitop3_b32 v10, v80, v84, v219 bitop3:0x96
  buffer_load_dwordx4 v[116:119], v2, s[36:39], s56 offen offset:1024 sc1
  v_cmp_ne_u16 vcc, v10, v5
  v_mfma_f32_32x32x16_bf16 v[160:175], a[124:127], v[76:79], v[160:175]
  ds_write_b128 v9, a[224:227] offset:4096
  s_cbranch_vccnz L_f4_r22
L_f4_ok22:
  v_mfma_f32_32x32x16_bf16 v[144:159], a[128:131], v[80:83], v[144:159]
  s_add_u32 s56, s54, 104448
  buffer_load_dwordx4 v[120:123], v2, s[36:39], s56 offen sc1
  ds_write_b128 v9, a[228:231] offset:5120
  v_mfma_f32_32x32x16_bf16 v[160:175], a[132:135], v[80:83], v[160:175]
  buffer_load_ushort v247, v0, s[36:39], s56 offen offset:2048 sc1
  v_mfma_f32_32x32x16_bf16 v[144:159], a[136:139], v[84:87], v[144:159]
  s_waitcnt vmcnt(11)
  v_bitop3_b32 v10, v88, v92, v130 bitop3:0x96
  ds_write_b128 v9, a[232:235] offset:6144
  buffer_load_dwordx4 v[124:127], v2, s[36:39], s56 offen offset:1024 sc1
  v_cmp_ne_u16 vcc, v10, v5
  v_mfma_f32_32x32x16_bf16 v[160:175], a[140:143], v[84:87], v[160:175]
  s_cbranch_vccnz L_f4_r23
L_f4_ok23:
  ds_write_b128 v9, a[236:239] offset:7168
  v_mfma_f32_32x32x16_bf16 v[144:159], a[144:147], v[88:91], v[144:159]
  v_mfma_f32_32x32x16_bf16 v[160:175], a[148:151], v[88:91], v[160:175]
  ds_write_b128 v14, a[240:243] offset:12288
  v_mfma_f32_32x32x16_bf16 v[144:159], a[152:155], v[92:95], v[144:159]
  s_waitcnt vmcnt(9)
  v_bitop3_b32 v10, v96, v100, v242 bitop3:0x96
  ds_write_b128 v14, a[244:247] offset:13312
  v_cmp_ne_u16 vcc, v10, v5
  v_mfma_f32_32x32x16_bf16 v[160:175], a[156:159], v[92:95], v[160:175]
  s_cbranch_vccnz L_f4_r24
L_f4_ok24:
  v_mfma_f32_32x32x16_bf16 v[144:159], a[160:163], v[96:99], v[144:159]
  ds_write_b128 v14, a[248:251] offset:14336
  v_mfma_f32_32x32x16_bf16 v[160:175], a[164:167], v[96:99], v[160:175]
  ds_write_b128 v14, a[252:255] offset:15360
  v_mfma_f32_32x32x16_bf16 v[144:159], a[168:171], v[100:103], v[144:159]
  s_waitcnt vmcnt(6)
  v_bitop3_b32 v10, v104, v108, v246 bitop3:0x96
  v_cmp_ne_u16 vcc, v10, v5
  v_mfma_f32_32x32x16_bf16 v[160:175], a[172:175], v[100:103], v[160:175]
  s_cbranch_vccnz L_f4_r25
L_f4_ok25:
  v_mfma_f32_32x32x16_bf16 v[144:159], a[176:179], v[104:107], v[144:159]
  s_waitcnt lgkmcnt(0)
  s_barrier
  ds_read_b128 v[176:179], v13 offset:4096
  ds_read_b128 v[180:183], v13 offset:5120
  v_mfma_f32_32x32x16_bf16 v[160:175], a[180:183], v[104:107], v[160:175]
  ds_read_b128 v[184:187], v13 offset:6144
  ds_read_b128 v[188:191], v13 offset:7168
  v_mfma_f32_32x32x16_bf16 v[144:159], a[184:187], v[108:111], v[144:159]
  s_waitcnt vmcnt(3)
  v_bitop3_b32 v10, v112, v116, v243 bitop3:0x96
  ds_read_b128 v[192:195], v13 offset:12288
  ds_read_b128 v[196:199], v13 offset:13312
  v_cmp_ne_u16 vcc, v10, v5
  v_mfma_f32_32x32x16_bf16 v[160:175], a[188:191], v[108:111], v[160:175]
  ds_read_b128 v[200:203], v13 offset:14336
  s_cbranch_vccnz L_f4_r26
L_f4_ok26:
  ds_read_b128 v[204:207], v13 offset:15360
  v_mfma_f32_32x32x16_bf16 v[144:159], a[192:195], v[112:115], v[144:159]
  v_mfma_f32_32x32x16_bf16 v[160:175], a[196:199], v[112:115], v[160:175]
  v_mfma_f32_32x32x16_bf16 v[144:159], a[200:203], v[116:119], v[144:159]
  s_waitcnt vmcnt(0)
  v_bitop3_b32 v10, v120, v124, v247 bitop3:0x96
  v_cmp_ne_u16 vcc, v10, v5
  v_mfma_f32_32x32x16_bf16 v[160:175], a[204:207], v[116:119], v[160:175]
  s_waitcnt lgkmcnt(3)
  v_add_f32 v176, v176, v192
  v_add_f32 v177, v177, v193
  s_cbranch_vccnz L_f4_r27
L_f4_ok27:
  v_add_f32 v178, v178, v194
  v_add_f32 v179, v179, v195
  v_mfma_f32_32x32x16_bf16 v[144:159], a[208:211], v[120:123], v[144:159]
  s_waitcnt lgkmcnt(2)
  v_add_f32 v180, v180, v196
  v_add_f32 v181, v181, v197
  v_add_f32 v182, v182, v198
  v_mfma_f32_32x32x16_bf16 v[160:175], a[212:215], v[120:123], v[160:175]
  v_add_f32 v183, v183, v199
  s_waitcnt lgkmcnt(1)
  v_add_f32 v184, v184, v200
  v_add_f32 v185, v185, v201
  v_mfma_f32_32x32x16_bf16 v[144:159], a[216:219], v[124:127], v[144:159]
  v_add_f32 v186, v186, v202
  v_add_f32 v187, v187, v203
  s_waitcnt lgkmcnt(0)
  v_add_f32 v188, v188, v204
  v_mfma_f32_32x32x16_bf16 v[160:175], a[220:223], v[124:127], v[160:175]
  v_add_f32 v189, v189, v205
  v_add_f32 v190, v190, v206
  v_add_f32 v191, v191, v207
  s_nop 8
  ds_write_b128 v12, v[160:163] offset:8192
  ds_write_b128 v12, v[164:167] offset:9216
  ds_write_b128 v12, v[168:171] offset:10240
  ds_write_b128 v12, v[172:175] offset:11264
  s_waitcnt lgkmcnt(0)
  s_barrier
  s_nop 0
  ds_read_b128 v[192:195], v13 offset:8192
  ds_read_b128 v[196:199], v13 offset:9216
  ds_read_b128 v[200:203], v13 offset:10240
  ds_read_b128 v[204:207], v13 offset:11264
  v_pk_add_f32 v[144:145], v[144:145], v[176:177]
  v_pk_add_f32 v[146:147], v[146:147], v[178:179]
  v_pk_add_f32 v[148:149], v[148:149], v[180:181]
  v_pk_add_f32 v[150:151], v[150:151], v[182:183]
  v_pk_add_f32 v[152:153], v[152:153], v[184:185]
  v_pk_add_f32 v[154:155], v[154:155], v[186:187]
  v_pk_add_f32 v[156:157], v[156:157], v[188:189]
  v_pk_add_f32 v[158:159], v[158:159], v[190:191]
  s_waitcnt lgkmcnt(3)
  v_pk_add_f32 v[144:145], v[144:145], v[192:193]
  v_pk_add_f32 v[146:147], v[146:147], v[194:195]
  s_waitcnt lgkmcnt(2)
  v_pk_add_f32 v[148:149], v[148:149], v[196:197]
  v_pk_add_f32 v[150:151], v[150:151], v[198:199]
  v_cvt_pk_bf16_f32 v96, v144, v145
  v_cvt_pk_bf16_f32 v97, v146, v147
  v_cvt_pk_bf16_f32 v98, v148, v149
  v_cvt_pk_bf16_f32 v99, v150, v151
  s_nop 0
  v_permlane32_swap_b32 v96, v98
  v_permlane32_swap_b32 v97, v99
  buffer_store_dwordx4 v[96:99], v7, s[32:35], s87 offen offset:0
  s_waitcnt lgkmcnt(1)
  v_pk_add_f32 v[152:153], v[152:153], v[200:201]
  v_pk_add_f32 v[154:155], v[154:155], v[202:203]
  s_waitcnt lgkmcnt(0)
  s_nop 0
  v_pk_add_f32 v[156:157], v[156:157], v[204:205]
  v_pk_add_f32 v[158:159], v[158:159], v[206:207]
  v_cvt_pk_bf16_f32 v100, v152, v153
  v_cvt_pk_bf16_f32 v101, v154, v155
  v_cvt_pk_bf16_f32 v102, v156, v157
  v_cvt_pk_bf16_f32 v103, v158, v159
  s_nop 0
  v_permlane32_swap_b32 v100, v102
  v_permlane32_swap_b32 v101, v103
  buffer_store_dwordx4 v[100:103], v7, s[32:35], s87 offen offset:32
  s_cmp_lg_u32 s2, 0
  s_cbranch_scc1 L_ex0
  v_mov_b32 v9, 0
  buffer_store_dword v5, v9, s[36:39], 0 offen sc1
L_ex0:
L_exit:
L_end:
  s_endpgm
L_fp_retry:
  v_bitop3_b32 v10, v16, v80, v142 bitop3:0x96
  v_bitop3_b32 v9, v20, v81, v142 bitop3:0x96
  v_or_b32 v10, v10, v9
  v_bitop3_b32 v9, v24, v82, v142 bitop3:0x96
  v_or_b32 v10, v10, v9
  v_bitop3_b32 v9, v28, v83, v142 bitop3:0x96
  v_or_b32 v10, v10, v9
  v_cmp_ne_u16 vcc, 0, v10
  s_cbranch_vccz L_fp_k0
  s_add_u32 s72, s50, 0
  buffer_load_dwordx4 v[16:19], v134, s[36:39], s72 offen sc1
  buffer_load_ushort v80, v135, s[36:39], s72 offen sc1
  s_add_u32 s72, s50, 4608
  buffer_load_dwordx4 v[20:23], v134, s[36:39], s72 offen sc1
  buffer_load_ushort v81, v135, s[36:39], s72 offen sc1
  s_add_u32 s72, s50, 9216
  buffer_load_dwordx4 v[24:27], v134, s[36:39], s72 offen sc1
  buffer_load_ushort v82, v135, s[36:39], s72 offen sc1
  s_add_u32 s72, s50, 13824
  buffer_load_dwordx4 v[28:31], v134, s[36:39], s72 offen sc1
  buffer_load_ushort v83, v135, s[36:39], s72 offen sc1
L_fp_k0:
  v_bitop3_b32 v10, v32, v84, v142 bitop3:0x96
  v_bitop3_b32 v9, v36, v85, v142 bitop3:0x96
  v_or_b32 v10, v10, v9
  v_bitop3_b32 v9, v40, v86, v142 bitop3:0x96
  v_or_b32 v10, v10, v9
  v_bitop3_b32 v9, v44, v87, v142 bitop3:0x96
  v_or_b32 v10, v10, v9
  v_cmp_ne_u16 vcc, 0, v10
  s_cbranch_vccz L_fp_k1
  s_add_u32 s72, s51, 0
  buffer_load_dwordx4 v[32:35], v134, s[36:39], s72 offen sc1
  buffer_load_ushort v84, v135, s[36:39], s72 offen sc1
  s_add_u32 s72, s51, 4608
  buffer_load_dwordx4 v[36:39], v134, s[36:39], s72 offen sc1
  buffer_load_ushort v85, v135, s[36:39], s72 offen sc1
  s_add_u32 s72, s51, 9216
  buffer_load_dwordx4 v[40:43], v134, s[36:39], s72 offen sc1
  buffer_load_ushort v86, v135, s[36:39], s72 offen sc1
  s_add_u32 s72, s51, 13824
  buffer_load_dwordx4 v[44:47], v134, s[36:39], s72 offen sc1
  buffer_load_ushort v87, v135, s[36:39], s72 offen sc1
L_fp_k1:
  v_bitop3_b32 v10, v48, v88, v142 bitop3:0x96
  v_bitop3_b32 v9, v52, v89, v142 bitop3:0x96
  v_or_b32 v10, v10, v9
  v_bitop3_b32 v9, v56, v90, v142 bitop3:0x96
  v_or_b32 v10, v10, v9
  v_bitop3_b32 v9, v60, v91, v142 bitop3:0x96
  v_or_b32 v10, v10, v9
  v_cmp_ne_u16 vcc, 0, v10
  s_cbranch_vccz L_fp_k2
  s_add_u32 s72, s52, 0
  buffer_load_dwordx4 v[48:51], v134, s[36:39], s72 offen sc1
  buffer_load_ushort v88, v135, s[36:39], s72 offen sc1
  s_add_u32 s72, s52, 4608
  buffer_load_dwordx4 v[52:55], v134, s[36:39], s72 offen sc1
  buffer_load_ushort v89, v135, s[36:39], s72 offen sc1
  s_add_u32 s72, s52, 9216
  buffer_load_dwordx4 v[56:59], v134, s[36:39], s72 offen sc1
  buffer_load_ushort v90, v135, s[36:39], s72 offen sc1
  s_add_u32 s72, s52, 13824
  buffer_load_dwordx4 v[60:63], v134, s[36:39], s72 offen sc1
  buffer_load_ushort v91, v135, s[36:39], s72 offen sc1
L_fp_k2:
  v_bitop3_b32 v10, v64, v92, v142 bitop3:0x96
  v_bitop3_b32 v9, v68, v93, v142 bitop3:0x96
  v_or_b32 v10, v10, v9
  v_bitop3_b32 v9, v72, v94, v142 bitop3:0x96
  v_or_b32 v10, v10, v9
  v_bitop3_b32 v9, v76, v95, v142 bitop3:0x96
  v_or_b32 v10, v10, v9
  v_cmp_ne_u16 vcc, 0, v10
  s_cbranch_vccz L_fp_k3
  s_add_u32 s72, s53, 0
  buffer_load_dwordx4 v[64:67], v134, s[36:39], s72 offen sc1
  buffer_load_ushort v92, v135, s[36:39], s72 offen sc1
  s_add_u32 s72, s53, 4608
  buffer_load_dwordx4 v[68:71], v134, s[36:39], s72 offen sc1
  buffer_load_ushort v93, v135, s[36:39], s72 offen sc1
  s_add_u32 s72, s53, 9216
  buffer_load_dwordx4 v[72:75], v134, s[36:39], s72 offen sc1
  buffer_load_ushort v94, v135, s[36:39], s72 offen sc1
  s_add_u32 s72, s53, 13824
  buffer_load_dwordx4 v[76:79], v134, s[36:39], s72 offen sc1
  buffer_load_ushort v95, v135, s[36:39], s72 offen sc1
L_fp_k3:
  s_add_u32 s58, s58, 1
  s_cmp_gt_u32 s58, 0x40000
  s_cbranch_scc1 L_end
  s_waitcnt vmcnt(0)
  s_branch L_fp_go
L_fo_r0:
  s_add_u32 s72, s59, 0
  buffer_load_dwordx4 v[16:19], v2, s[36:39], s72 offen sc1
  buffer_load_dwordx4 v[20:23], v2, s[36:39], s72 offen offset:1024 sc1
  s_add_u32 s72, s59, 2048
  buffer_load_dwordx4 v[24:27], v2, s[36:39], s72 offen sc1
  buffer_load_dwordx4 v[28:31], v2, s[36:39], s72 offen offset:1024 sc1
  s_add_u32 s58, s58, 1
  s_cmp_gt_u32 s58, 0x40000
  s_cbranch_scc1 L_end
  s_waitcnt vmcnt(0)
  v_bitop3_b32 v10, v16, v23, s62 bitop3:0x28
  v_cmp_ne_u32 vcc, v10, v6
  s_cbranch_vccnz L_fo_r0
  s_branch L_fo_ok0
L_fo_r1:
  s_add_u32 s72, s59, 2048
  buffer_load_dwordx4 v[24:27], v2, s[36:39], s72 offen sc1
  buffer_load_dwordx4 v[28:31], v2, s[36:39], s72 offen offset:1024 sc1
  s_add_u32 s72, s59, 4096
  buffer_load_dwordx4 v[32:35], v2, s[36:39], s72 offen sc1
  buffer_load_dwordx4 v[36:39], v2, s[36:39], s72 offen offset:1024 sc1
  s_add_u32 s58, s58, 1
  s_cmp_gt_u32 s58, 0x40000
  s_cbranch_scc1 L_end
  s_waitcnt vmcnt(0)
  v_bitop3_b32 v10, v24, v31, s62 bitop3:0x28
  v_cmp_ne_u32 vcc, v10, v6
  s_cbranch_vccnz L_fo_r1
  s_branch L_fo_ok1
L_fo_r2:
  s_add_u32 s72, s59, 4096
  buffer_load_dwordx4 v[32:35], v2, s[36:39], s72 offen sc1
  buffer_load_dwordx4 v[36:39], v2, s[36:39], s72 offen offset:1024 sc1
  s_add_u32 s72, s59, 6144
  buffer_load_dwordx4 v[40:43], v2, s[36:39], s72 offen sc1
  buffer_load_dwordx4 v[44:47], v2, s[36:39], s72 offen offset:1024 sc1
  s_add_u32 s58, s58, 1
  s_cmp_gt_u32 s58, 0x40000
  s_cbranch_scc1 L_end
  s_waitcnt vmcnt(0)
  v_bitop3_b32 v10, v32, v39, s62 bitop3:0x28
  v_cmp_ne_u32 vcc, v10, v6
  s_cbranch_vccnz L_fo_r2
  s_branch L_fo_ok2
L_fo_r3:
  s_add_u32 s72, s59, 6144
  buffer_load_dwordx4 v[40:43], v2, s[36:39], s72 offen sc1
  buffer_load_dwordx4 v[44:47], v2, s[36:39], s72 offen offset:1024 sc1
  s_add_u32 s58, s58, 1
  s_cmp_gt_u32 s58, 0x40000
  s_cbranch_scc1 L_end
  s_waitcnt vmcnt(0)
  v_bitop3_b32 v10, v40, v47, s62 bitop3:0x28
  v_cmp_ne_u32 vcc, v10, v6
  s_cbranch_vccnz L_fo_r3
  s_branch L_fo_ok3
L_fo_r4:
  s_add_u32 s72, s50, 0
  buffer_load_dwordx4 v[48:51], v2, s[36:39], s72 offen sc1
  buffer_load_dwordx4 v[52:55], v2, s[36:39], s72 offen offset:1024 sc1
  s_add_u32 s72, s50, 2048
  buffer_load_dwordx4 v[56:59], v2, s[36:39], s72 offen sc1
  buffer_load_dwordx4 v[60:63], v2, s[36:39], s72 offen offset:1024 sc1
  s_add_u32 s58, s58, 1
  s_cmp_gt_u32 s58, 0x40000
  s_cbranch_scc1 L_end
  s_waitcnt vmcnt(0)
  v_bitop3_b32 v10, v48, v55, s62 bitop3:0x28
  v_cmp_ne_u32 vcc, v10, v6
  s_cbranch_vccnz L_fo_r4
  s_branch L_fo_ok4
L_fo_r5:
  s_add_u32 s72, s50, 2048
  buffer_load_dwordx4 v[56:59], v2, s[36:39], s72 offen sc1
  buffer_load_dwordx4 v[60:63], v2, s[36:39], s72 offen offset:1024 sc1
  s_add_u32 s72, s50, 4096
  buffer_load_dwordx4 v[64:67], v2, s[36:39], s72 offen sc1
  buffer_load_dwordx4 v[68:71], v2, s[36:39], s72 offen offset:1024 sc1
  s_add_u32 s58, s58, 1
  s_cmp_gt_u32 s58, 0x40000
  s_cbranch_scc1 L_end
  s_waitcnt vmcnt(0)
  v_bitop3_b32 v10, v56, v63, s62 bitop3:0x28
  v_cmp_ne_u32 vcc, v10, v6
  s_cbranch_vccnz L_fo_r5
  s_branch L_fo_ok5
L_fo_r6:
  s_add_u32 s72, s50, 4096
  buffer_load_dwordx4 v[64:67], v2, s[36:39], s72 offen sc1
  buffer_load_dwordx4 v[68:71], v2, s[36:39], s72 offen offset:1024 sc1
  s_add_u32 s72, s50, 6144
  buffer_load_dwordx4 v[72:75], v2, s[36:39], s72 offen sc1
  buffer_load_dwordx4 v[76:79], v2, s[36:39], s72 offen offset:1024 sc1
  s_add_u32 s58, s58, 1
  s_cmp_gt_u32 s58, 0x40000
  s_cbranch_scc1 L_end
  s_waitcnt vmcnt(0)
  v_bitop3_b32 v10, v64, v71, s62 bitop3:0x28
  v_cmp_ne_u32 vcc, v10, v6
  s_cbranch_vccnz L_fo_r6
  s_branch L_fo_ok6
L_fo_r7:
  s_add_u32 s72, s50, 6144
  buffer_load_dwordx4 v[72:75], v2, s[36:39], s72 offen sc1
  buffer_load_dwordx4 v[76:79], v2, s[36:39], s72 offen offset:1024 sc1
  s_add_u32 s58, s58, 1
  s_cmp_gt_u32 s58, 0x40000
  s_cbranch_scc1 L_end
  s_waitcnt vmcnt(0)
  v_bitop3_b32 v10, v72, v79, s62 bitop3:0x28
  v_cmp_ne_u32 vcc, v10, v6
  s_cbranch_vccnz L_fo_r7
  s_branch L_fo_ok7
L_fh_r0:
  s_add_u32 s72, s59, 0
  buffer_load_dwordx4 v[16:19], v2, s[36:39], s72 offen sc1
  buffer_load_dwordx4 v[20:23], v2, s[36:39], s72 offen offset:1024 sc1
  buffer_load_dword v192, v4, s[36:39], s72 offen offset:2048 sc1
  buffer_load_ushort v193, v0, s[36:39], s72 offen offset:2304 sc1
  s_add_u32 s72, s59, 2432
  buffer_load_dwordx4 v[24:27], v2, s[36:39], s72 offen sc1
  buffer_load_dwordx4 v[28:31], v2, s[36:39], s72 offen offset:1024 sc1
  buffer_load_dword v194, v4, s[36:39], s72 offen offset:2048 sc1
  buffer_load_ushort v195, v0, s[36:39], s72 offen offset:2304 sc1
  s_add_u32 s58, s58, 1
  s_cmp_gt_u32 s58, 0x40000
  s_cbranch_scc1 L_end
  s_waitcnt vmcnt(0)
  v_bitop3_b32 v10, v16, v20, v192 bitop3:0x96
  v_xor_b32 v10, v10, v193
  v_cmp_ne_u16 vcc, v10, v5
  s_cbranch_vccnz L_fh_r0
  s_branch L_fh_ok0
L_fh_r1:
  s_add_u32 s72, s59, 2432
  buffer_load_dwordx4 v[24:27], v2, s[36:39], s72 offen sc1
  buffer_load_dwordx4 v[28:31], v2, s[36:39], s72 offen offset:1024 sc1
  buffer_load_dword v194, v4, s[36:39], s72 offen offset:2048 sc1
  buffer_load_ushort v195, v0, s[36:39], s72 offen offset:2304 sc1
  s_add_u32 s72, s59, 4864
  buffer_load_dwordx4 v[32:35], v2, s[36:39], s72 offen sc1
  buffer_load_dwordx4 v[36:39], v2, s[36:39], s72 offen offset:1024 sc1
  buffer_load_dword v196, v4, s[36:39], s72 offen offset:2048 sc1
  buffer_load_ushort v197, v0, s[36:39], s72 offen offset:2304 sc1
  s_add_u32 s58, s58, 1
  s_cmp_gt_u32 s58, 0x40000
  s_cbranch_scc1 L_end
  s_waitcnt vmcnt(0)
  v_bitop3_b32 v10, v24, v28, v194 bitop3:0x96
  v_xor_b32 v10, v10, v195
  v_cmp_ne_u16 vcc, v10, v5
  s_cbranch_vccnz L_fh_r1
  s_branch L_fh_ok1
L_fh_r2:
  s_add_u32 s72, s59, 4864
  buffer_load_dwordx4 v[32:35], v2, s[36:39], s72 offen sc1
  buffer_load_dwordx4 v[36:39], v2, s[36:39], s72 offen offset:1024 sc1
  buffer_load_dword v196, v4, s[36:39], s72 offen offset:2048 sc1
  buffer_load_ushort v197, v0, s[36:39], s72 offen offset:2304 sc1
  s_add_u32 s72, s59, 7296
  buffer_load_dwordx4 v[40:43], v2, s[36:39], s72 offen sc1
  buffer_load_dwordx4 v[44:47], v2, s[36:39], s72 offen offset:1024 sc1
  buffer_load_dword v198, v4, s[36:39], s72 offen offset:2048 sc1
  buffer_load_ushort v199, v0, s[36:39], s72 offen offset:2304 sc1
  s_add_u32 s58, s58, 1
  s_cmp_gt_u32 s58, 0x40000
  s_cbranch_scc1 L_end
  s_waitcnt vmcnt(0)
  v_bitop3_b32 v10, v32, v36, v196 bitop3:0x96
  v_xor_b32 v10, v10, v197
  v_cmp_ne_u16 vcc, v10, v5
  s_cbranch_vccnz L_fh_r2
  s_branch L_fh_ok2
L_fh_r3:
  s_add_u32 s72, s59, 7296
  buffer_load_dwordx4 v[40:43], v2, s[36:39], s72 offen sc1
  buffer_load_dwordx4 v[44:47], v2, s[36:39], s72 offen offset:1024 sc1
  buffer_load_dword v198, v4, s[36:39], s72 offen offset:2048 sc1
  buffer_load_ushort v199, v0, s[36:39], s72 offen offset:2304 sc1
  s_add_u32 s72, s59, 9728
  buffer_load_dwordx4 v[48:51], v2, s[36:39], s72 offen sc1
  buffer_load_dwordx4 v[52:55], v2, s[36:39], s72 offen offset:1024 sc1
  buffer_load_dword v200, v4, s[36:39], s72 offen offset:2048 sc1
  buffer_load_ushort v201, v0, s[36:39], s72 offen offset:2304 sc1
  s_add_u32 s58, s58, 1
  s_cmp_gt_u32 s58, 0x40000
  s_cbranch_scc1 L_end
  s_waitcnt vmcnt(0)
  v_bitop3_b32 v10, v40, v44, v198 bitop3:0x96
  v_xor_b32 v10, v10, v199
  v_cmp_ne_u16 vcc, v10, v5
  s_cbranch_vccnz L_fh_r3
  s_branch L_fh_ok3
L_fh_r4:
  s_add_u32 s72, s59, 9728
  buffer_load_dwordx4 v[48:51], v2, s[36:39], s72 offen sc1
  buffer_load_dwordx4 v[52:55], v2, s[36:39], s72 offen offset:1024 sc1
  buffer_load_dword v200, v4, s[36:39], s72 offen offset:2048 sc1
  buffer_load_ushort v201, v0, s[36:39], s72 offen offset:2304 sc1
  s_add_u32 s72, s59, 12160
  buffer_load_dwordx4 v[56:59], v2, s[36:39], s72 offen sc1
  buffer_load_dwordx4 v[60:63], v2, s[36:39], s72 offen offset:1024 sc1
  buffer_load_dword v202, v4, s[36:39], s72 offen offset:2048 sc1
  buffer_load_ushort v203, v0, s[36:39], s72 offen offset:2304 sc1
  s_add_u32 s58, s58, 1
  s_cmp_gt_u32 s58, 0x40000
  s_cbranch_scc1 L_end
  s_waitcnt vmcnt(0)
  v_bitop3_b32 v10, v48, v52, v200 bitop3:0x96
  v_xor_b32 v10, v10, v201
  v_cmp_ne_u16 vcc, v10, v5
  s_cbranch_vccnz L_fh_r4
  s_branch L_fh_ok4
L_fh_r5:
  s_add_u32 s72, s59, 12160
  buffer_load_dwordx4 v[56:59], v2, s[36:39], s72 offen sc1
  buffer_load_dwordx4 v[60:63], v2, s[36:39], s72 offen offset:1024 sc1
  buffer_load_dword v202, v4, s[36:39], s72 offen offset:2048 sc1
  buffer_load_ushort v203, v0, s[36:39], s72 offen offset:2304 sc1
  s_add_u32 s72, s59, 14592
  buffer_load_dwordx4 v[64:67], v2, s[36:39], s72 offen sc1
  buffer_load_dwordx4 v[68:71], v2, s[36:39], s72 offen offset:1024 sc1
  buffer_load_dword v204, v4, s[36:39], s72 offen offset:2048 sc1
  buffer_load_ushort v205, v0, s[36:39], s72 offen offset:2304 sc1
  s_add_u32 s58, s58, 1
  s_cmp_gt_u32 s58, 0x40000
  s_cbranch_scc1 L_end
  s_waitcnt vmcnt(0)
  v_bitop3_b32 v10, v56, v60, v202 bitop3:0x96
  v_xor_b32 v10, v10, v203
  v_cmp_ne_u16 vcc, v10, v5
  s_cbranch_vccnz L_fh_r5
  s_branch L_fh_ok5
L_fh_r6:
  s_add_u32 s72, s59, 14592
  buffer_load_dwordx4 v[64:67], v2, s[36:39], s72 offen sc1
  buffer_load_dwordx4 v[68:71], v2, s[36:39], s72 offen offset:1024 sc1
  buffer_load_dword v204, v4, s[36:39], s72 offen offset:2048 sc1
  buffer_load_ushort v205, v0, s[36:39], s72 offen offset:2304 sc1
  s_add_u32 s72, s59, 17024
  buffer_load_dwordx4 v[72:75], v2, s[36:39], s72 offen sc1
  buffer_load_dwordx4 v[76:79], v2, s[36:39], s72 offen offset:1024 sc1
  buffer_load_dword v206, v4, s[36:39], s72 offen offset:2048 sc1
  buffer_load_ushort v207, v0, s[36:39], s72 offen offset:2304 sc1
  s_add_u32 s58, s58, 1
  s_cmp_gt_u32 s58, 0x40000
  s_cbranch_scc1 L_end
  s_waitcnt vmcnt(0)
  v_bitop3_b32 v10, v64, v68, v204 bitop3:0x96
  v_xor_b32 v10, v10, v205
  v_cmp_ne_u16 vcc, v10, v5
  s_cbranch_vccnz L_fh_r6
  s_branch L_fh_ok6
L_fh_r7:
  s_add_u32 s72, s59, 17024
  buffer_load_dwordx4 v[72:75], v2, s[36:39], s72 offen sc1
  buffer_load_dwordx4 v[76:79], v2, s[36:39], s72 offen offset:1024 sc1
  buffer_load_dword v206, v4, s[36:39], s72 offen offset:2048 sc1
  buffer_load_ushort v207, v0, s[36:39], s72 offen offset:2304 sc1
  s_add_u32 s72, s59, 19456
  buffer_load_dwordx4 v[80:83], v2, s[36:39], s72 offen sc1
  buffer_load_dwordx4 v[84:87], v2, s[36:39], s72 offen offset:1024 sc1
  buffer_load_dword v208, v4, s[36:39], s72 offen offset:2048 sc1
  buffer_load_ushort v209, v0, s[36:39], s72 offen offset:2304 sc1
  s_add_u32 s58, s58, 1
  s_cmp_gt_u32 s58, 0x40000
  s_cbranch_scc1 L_end
  s_waitcnt vmcnt(0)
  v_bitop3_b32 v10, v72, v76, v206 bitop3:0x96
  v_xor_b32 v10, v10, v207
  v_cmp_ne_u16 vcc, v10, v5
  s_cbranch_vccnz L_fh_r7
  s_branch L_fh_ok7
L_fh_r8:
  s_add_u32 s72, s59, 19456
  buffer_load_dwordx4 v[80:83], v2, s[36:39], s72 offen sc1
  buffer_load_dwordx4 v[84:87], v2, s[36:39], s72 offen offset:1024 sc1
  buffer_load_dword v208, v4, s[36:39], s72 offen offset:2048 sc1
  buffer_load_ushort v209, v0, s[36:39], s72 offen offset:2304 sc1
  s_add_u32 s72, s59, 21888
  buffer_load_dwordx4 v[88:91], v2, s[36:39], s72 offen sc1
  buffer_load_dwordx4 v[92:95], v2, s[36:39], s72 offen offset:1024 sc1
  buffer_load_dword v210, v4, s[36:39], s72 offen offset:2048 sc1
  buffer_load_ushort v211, v0, s[36:39], s72 offen offset:2304 sc1
  s_add_u32 s58, s58, 1
  s_cmp_gt_u32 s58, 0x40000
  s_cbranch_scc1 L_end
  s_waitcnt vmcnt(0)
  v_bitop3_b32 v10, v80, v84, v208 bitop3:0x96
  v_xor_b32 v10, v10, v209
  v_cmp_ne_u16 vcc, v10, v5
  s_cbranch_vccnz L_fh_r8
  s_branch L_fh_ok8
L_fh_r9:
  s_add_u32 s72, s59, 21888
  buffer_load_dwordx4 v[88:91], v2, s[36:39], s72 offen sc1
  buffer_load_dwordx4 v[92:95], v2, s[36:39], s72 offen offset:1024 sc1
  buffer_load_dword v210, v4, s[36:39], s72 offen offset:2048 sc1
  buffer_load_ushort v211, v0, s[36:39], s72 offen offset:2304 sc1
  s_add_u32 s72, s59, 24320
  buffer_load_dwordx4 v[96:99], v2, s[36:39], s72 offen sc1
  buffer_load_dwordx4 v[100:103], v2, s[36:39], s72 offen offset:1024 sc1
  buffer_load_dword v212, v4, s[36:39], s72 offen offset:2048 sc1
  buffer_load_ushort v213, v0, s[36:39], s72 offen offset:2304 sc1
  s_add_u32 s58, s58, 1
  s_cmp_gt_u32 s58, 0x40000
  s_cbranch_scc1 L_end
  s_waitcnt vmcnt(0)
  v_bitop3_b32 v10, v88, v92, v210 bitop3:0x96
  v_xor_b32 v10, v10, v211
  v_cmp_ne_u16 vcc, v10, v5
  s_cbranch_vccnz L_fh_r9
  s_branch L_fh_ok9
L_fh_r10:
  s_add_u32 s72, s59, 24320
  buffer_load_dwordx4 v[96:99], v2, s[36:39], s72 offen sc1
  buffer_load_dwordx4 v[100:103], v2, s[36:39], s72 offen offset:1024 sc1
  buffer_load_dword v212, v4, s[36:39], s72 offen offset:2048 sc1
  buffer_load_ushort v213, v0, s[36:39], s72 offen offset:2304 sc1
  s_add_u32 s72, s59, 26752
  buffer_load_dwordx4 v[104:107], v2, s[36:39], s72 offen sc1
  buffer_load_dwordx4 v[108:111], v2, s[36:39], s72 offen offset:1024 sc1
  buffer_load_dword v214, v4, s[36:39], s72 offen offset:2048 sc1
  buffer_load_ushort v215, v0, s[36:39], s72 offen offset:2304 sc1
  s_add_u32 s58, s58, 1
  s_cmp_gt_u32 s58, 0x40000
  s_cbranch_scc1 L_end
  s_waitcnt vmcnt(0)
  v_bitop3_b32 v10, v96, v100, v212 bitop3:0x96
  v_xor_b32 v10, v10, v213
  v_cmp_ne_u16 vcc, v10, v5
  s_cbranch_vccnz L_fh_r10
  s_branch L_fh_ok10
L_fh_r11:
  s_add_u32 s72, s59, 26752
  buffer_load_dwordx4 v[104:107], v2, s[36:39], s72 offen sc1
  buffer_load_dwordx4 v[108:111], v2, s[36:39], s72 offen offset:1024 sc1
  buffer_load_dword v214, v4, s[36:39], s72 offen offset:2048 sc1
  buffer_load_ushort v215, v0, s[36:39], s72 offen offset:2304 sc1
  s_add_u32 s72, s59, 29184
  buffer_load_dwordx4 v[112:115], v2, s[36:39], s72 offen sc1
  buffer_load_dwordx4 v[116:119], v2, s[36:39], s72 offen offset:1024 sc1
  buffer_load_dword v216, v4, s[36:39], s72 offen offset:2048 sc1
  buffer_load_ushort v217, v0, s[36:39], s72 offen offset:2304 sc1
  s_add_u32 s58, s58, 1
  s_cmp_gt_u32 s58, 0x40000
  s_cbranch_scc1 L_end
  s_waitcnt vmcnt(0)
  v_bitop3_b32 v10, v104, v108, v214 bitop3:0x96
  v_xor_b32 v10, v10, v215
  v_cmp_ne_u16 vcc, v10, v5
  s_cbranch_vccnz L_fh_r11
  s_branch L_fh_ok11
L_fh_r12:
  s_add_u32 s72, s59, 29184
  buffer_load_dwordx4 v[112:115], v2, s[36:39], s72 offen sc1
  buffer_load_dwordx4 v[116:119], v2, s[36:39], s72 offen offset:1024 sc1
  buffer_load_dword v216, v4, s[36:39], s72 offen offset:2048 sc1
  buffer_load_ushort v217, v0, s[36:39], s72 offen offset:2304 sc1
  s_add_u32 s72, s59, 31616
  buffer_load_dwordx4 v[120:123], v2, s[36:39], s72 offen sc1
  buffer_load_dwordx4 v[124:127], v2, s[36:39], s72 offen offset:1024 sc1
  buffer_load_dword v218, v4, s[36:39], s72 offen offset:2048 sc1
  buffer_load_ushort v219, v0, s[36:39], s72 offen offset:2304 sc1
  s_add_u32 s58, s58, 1
  s_cmp_gt_u32 s58, 0x40000
  s_cbranch_scc1 L_end
  s_waitcnt vmcnt(0)
  v_bitop3_b32 v10, v112, v116, v216 bitop3:0x96
  v_xor_b32 v10, v10, v217
  v_cmp_ne_u16 vcc, v10, v5
  s_cbranch_vccnz L_fh_r12
  s_branch L_fh_ok12
L_fh_r13:
  s_add_u32 s72, s59, 31616
  buffer_load_dwordx4 v[120:123], v2, s[36:39], s72 offen sc1
  buffer_load_dwordx4 v[124:127], v2, s[36:39], s72 offen offset:1024 sc1
  buffer_load_dword v218, v4, s[36:39], s72 offen offset:2048 sc1
  buffer_load_ushort v219, v0, s[36:39], s72 offen offset:2304 sc1
  s_add_u32 s58, s58, 1
  s_cmp_gt_u32 s58, 0x40000
  s_cbranch_scc1 L_end
  s_waitcnt vmcnt(0)
  v_bitop3_b32 v10, v120, v124, v218 bitop3:0x96
  v_xor_b32 v10, v10, v219
  v_cmp_ne_u16 vcc, v10, v5
  s_cbranch_vccnz L_fh_r13
  s_branch L_fh_ok13
L_f4_r0:
  s_add_u32 s72, s51, 0
  buffer_load_dwordx4 v[16:19], v2, s[36:39], s72 offen sc1
  buffer_load_dwordx4 v[20:23], v2, s[36:39], s72 offen offset:1024 sc1
  buffer_load_ushort v240, v0, s[36:39], s72 offen offset:2048 sc1
  s_add_u32 s72, s51, 17408
  buffer_load_dwordx4 v[24:27], v2, s[36:39], s72 offen sc1
  buffer_load_dwordx4 v[28:31], v2, s[36:39], s72 offen offset:1024 sc1
  buffer_load_ushort v241, v0, s[36:39], s72 offen offset:2048 sc1
  s_add_u32 s72, s51, 34816
  buffer_load_dwordx4 v[32:35], v2, s[36:39], s72 offen sc1
  buffer_load_dwordx4 v[36:39], v2, s[36:39], s72 offen offset:1024 sc1
  buffer_load_ushort v244, v0, s[36:39], s72 offen offset:2048 sc1
  s_add_u32 s58, s58, 1
  s_cmp_gt_u32 s58, 0x40000
  s_cbranch_scc1 L_end
  s_waitcnt vmcnt(0)
  v_bitop3_b32 v10, v16, v20, v240 bitop3:0x96
  v_cmp_ne_u16 vcc, v10, v5
  s_cbranch_vccnz L_f4_r0
  s_branch L_f4_ok0
L_f4_r1:
  s_add_u32 s72, s51, 17408
  buffer_load_dwordx4 v[24:27], v2, s[36:39], s72 offen sc1
  buffer_load_dwordx4 v[28:31], v2, s[36:39], s72 offen offset:1024 sc1
  buffer_load_ushort v241, v0, s[36:39], s72 offen offset:2048 sc1
  s_add_u32 s72, s51, 34816
  buffer_load_dwordx4 v[32:35], v2, s[36:39], s72 offen sc1
  buffer_load_dwordx4 v[36:39], v2, s[36:39], s72 offen offset:1024 sc1
  buffer_load_ushort v244, v0, s[36:39], s72 offen offset:2048 sc1
  s_add_u32 s72, s51, 52224
  buffer_load_dwordx4 v[40:43], v2, s[36:39], s72 offen sc1
  buffer_load_dwordx4 v[44:47], v2, s[36:39], s72 offen offset:1024 sc1
  buffer_load_ushort v245, v0, s[36:39], s72 offen offset:2048 sc1
  s_add_u32 s58, s58, 1
  s_cmp_gt_u32 s58, 0x40000
  s_cbranch_scc1 L_end
  s_waitcnt vmcnt(0)
  v_bitop3_b32 v10, v24, v28, v241 bitop3:0x96
  v_cmp_ne_u16 vcc, v10, v5
  s_cbranch_vccnz L_f4_r1
  s_branch L_f4_ok1
L_f4_r2:
  s_add_u32 s72, s51, 34816
  buffer_load_dwordx4 v[32:35], v2, s[36:39], s72 offen sc1
  buffer_load_dwordx4 v[36:39], v2, s[36:39], s72 offen offset:1024 sc1
  buffer_load_ushort v244, v0, s[36:39], s72 offen offset:2048 sc1
  s_add_u32 s72, s51, 52224
  buffer_load_dwordx4 v[40:43], v2, s[36:39], s72 offen sc1
  buffer_load_dwordx4 v[44:47], v2, s[36:39], s72 offen offset:1024 sc1
  buffer_load_ushort v245, v0, s[36:39], s72 offen offset:2048 sc1
  s_add_u32 s72, s51, 69632
  buffer_load_dwordx4 v[48:51], v2, s[36:39], s72 offen sc1
  buffer_load_dwordx4 v[52:55], v2, s[36:39], s72 offen offset:1024 sc1
  buffer_load_ushort v248, v0, s[36:39], s72 offen offset:2048 sc1
  s_add_u32 s58, s58, 1
  s_cmp_gt_u32 s58, 0x40000
  s_cbranch_scc1 L_end
  s_waitcnt vmcnt(0)
  v_bitop3_b32 v10, v32, v36, v244 bitop3:0x96
  v_cmp_ne_u16 vcc, v10, v5
  s_cbranch_vccnz L_f4_r2
  s_branch L_f4_ok2
L_f4_r3:
  s_add_u32 s72, s51, 52224
  buffer_load_dwordx4 v[40:43], v2, s[36:39], s72 offen sc1
  buffer_load_dwordx4 v[44:47], v2, s[36:39], s72 offen offset:1024 sc1
  buffer_load_ushort v245, v0, s[36:39], s72 offen offset:2048 sc1
  s_add_u32 s72, s51, 69632
  buffer_load_dwordx4 v[48:51], v2, s[36:39], s72 offen sc1
  buffer_load_dwordx4 v[52:55], v2, s[36:39], s72 offen offset:1024 sc1
  buffer_load_ushort v248, v0, s[36:39], s72 offen offset:2048 sc1
  s_add_u32 s72, s51, 87040
  buffer_load_dwordx4 v[56:59], v2, s[36:39], s72 offen sc1
  buffer_load_dwordx4 v[60:63], v2, s[36:39], s72 offen offset:1024 sc1
  buffer_load_ushort v249, v0, s[36:39], s72 offen offset:2048 sc1
  s_add_u32 s58, s58, 1
  s_cmp_gt_u32 s58, 0x40000
  s_cbranch_scc1 L_end
  s_waitcnt vmcnt(0)
  v_bitop3_b32 v10, v40, v44, v245 bitop3:0x96
  v_cmp_ne_u16 vcc, v10, v5
  s_cbranch_vccnz L_f4_r3
  s_branch L_f4_ok3
L_f4_r4:
  s_add_u32 s72, s51, 69632
  buffer_load_dwordx4 v[48:51], v2, s[36:39], s72 offen sc1
  buffer_load_dwordx4 v[52:55], v2, s[36:39], s72 offen offset:1024 sc1
  buffer_load_ushort v248, v0, s[36:39], s72 offen offset:2048 sc1
  s_add_u32 s72, s51, 87040
  buffer_load_dwordx4 v[56:59], v2, s[36:39], s72 offen sc1
  buffer_load_dwordx4 v[60:63], v2, s[36:39], s72 offen offset:1024 sc1
  buffer_load_ushort v249, v0, s[36:39], s72 offen offset:2048 sc1
  s_add_u32 s72, s51, 104448
  buffer_load_dwordx4 v[64:67], v2, s[36:39], s72 offen sc1
  buffer_load_dwordx4 v[68:71], v2, s[36:39], s72 offen offset:1024 sc1
  buffer_load_ushort v217, v0, s[36:39], s72 offen offset:2048 sc1
  s_add_u32 s58, s58, 1
  s_cmp_gt_u32 s58, 0x40000
  s_cbranch_scc1 L_end
  s_waitcnt vmcnt(0)
  v_bitop3_b32 v10, v48, v52, v248 bitop3:0x96
  v_cmp_ne_u16 vcc, v10, v5
  s_cbranch_vccnz L_f4_r4
  s_branch L_f4_ok4
L_f4_r5:
  s_add_u32 s72, s51, 87040
  buffer_load_dwordx4 v[56:59], v2, s[36:39], s72 offen sc1
  buffer_load_dwordx4 v[60:63], v2, s[36:39], s72 offen offset:1024 sc1
  buffer_load_ushort v249, v0, s[36:39], s72 offen offset:2048 sc1
  s_add_u32 s72, s51, 104448
  buffer_load_dwordx4 v[64:67], v2, s[36:39], s72 offen sc1
  buffer_load_dwordx4 v[68:71], v2, s[36:39], s72 offen offset:1024 sc1
  buffer_load_ushort v217, v0, s[36:39], s72 offen offset:2048 sc1
  s_add_u32 s72, s52, 0
  buffer_load_dwordx4 v[72:75], v2, s[36:39], s72 offen sc1
  buffer_load_dwordx4 v[76:79], v2, s[36:39], s72 offen offset:1024 sc1
  buffer_load_ushort v218, v0, s[36:39], s72 offen offset:2048 sc1
  s_add_u32 s58, s58, 1
  s_cmp_gt_u32 s58, 0x40000
  s_cbranch_scc1 L_end
  s_waitcnt vmcnt(0)
  v_bitop3_b32 v10, v56, v60, v249 bitop3:0x96
  v_cmp_ne_u16 vcc, v10, v5
  s_cbranch_vccnz L_f4_r5
  s_branch L_f4_ok5
L_f4_r6:
  s_add_u32 s72, s51, 104448
  buffer_load_dwordx4 v[64:67], v2, s[36:39], s72 offen sc1
  buffer_load_dwordx4 v[68:71], v2, s[36:39], s72 offen offset:1024 sc1
  buffer_load_ushort v217, v0, s[36:39], s72 offen offset:2048 sc1
  s_add_u32 s72, s52, 0
  buffer_load_dwordx4 v[72:75], v2, s[36:39], s72 offen sc1
  buffer_load_dwordx4 v[76:79], v2, s[36:39], s72 offen offset:1024 sc1
  buffer_load_ushort v218, v0, s[36:39], s72 offen offset:2048 sc1
  s_add_u32 s72, s52, 17408
  buffer_load_dwordx4 v[80:83], v2, s[36:39], s72 offen sc1
  buffer_load_dwordx4 v[84:87], v2, s[36:39], s72 offen offset:1024 sc1
  buffer_load_ushort v219, v0, s[36:39], s72 offen offset:2048 sc1
  s_add_u32 s58, s58, 1
  s_cmp_gt_u32 s58, 0x40000
  s_cbranch_scc1 L_end
  s_waitcnt vmcnt(0)
  v_bitop3_b32 v10, v64, v68, v217 bitop3:0x96
  v_cmp_ne_u16 vcc, v10, v5
  s_cbranch_vccnz L_f4_r6
  s_branch L_f4_ok6
L_f4_r7:
  s_add_u32 s72, s52, 0
  buffer_load_dwordx4 v[72:75], v2, s[36:39], s72 offen sc1
  buffer_load_dwordx4 v[76:79], v2, s[36:39], s72 offen offset:1024 sc1
  buffer_load_ushort v218, v0, s[36:39], s72 offen offset:2048 sc1
  s_add_u32 s72, s52, 17408
  buffer_load_dwordx4 v[80:83], v2, s[36:39], s72 offen sc1
  buffer_load_dwordx4 v[84:87], v2, s[36:39], s72 offen offset:1024 sc1
  buffer_load_ushort v219, v0, s[36:39], s72 offen offset:2048 sc1
  s_add_u32 s72, s52, 34816
  buffer_load_dwordx4 v[88:91], v2, s[36:39], s72 offen sc1
  buffer_load_dwordx4 v[92:95], v2, s[36:39], s72 offen offset:1024 sc1
  buffer_load_ushort v130, v0, s[36:39], s72 offen offset:2048 sc1
  s_add_u32 s58, s58, 1
  s_cmp_gt_u32 s58, 0x40000
  s_cbranch_scc1 L_end
  s_waitcnt vmcnt(0)
  v_bitop3_b32 v10, v72, v76, v218 bitop3:0x96
  v_cmp_ne_u16 vcc, v10, v5
  s_cbranch_vccnz L_f4_r7
  s_branch L_f4_ok7
L_f4_r8:
  s_add_u32 s72, s52, 17408
  buffer_load_dwordx4 v[80:83], v2, s[36:39], s72 offen sc1
  buffer_load_dwordx4 v[84:87], v2, s[36:39], s72 offen offset:1024 sc1
  buffer_load_ushort v219, v0, s[36:39], s72 offen offset:2048 sc1
  s_add_u32 s72, s52, 34816
  buffer_load_dwordx4 v[88:91], v2, s[36:39], s72 offen sc1
  buffer_load_dwordx4 v[92:95], v2, s[36:39], s72 offen offset:1024 sc1
  buffer_load_ushort v130, v0, s[36:39], s72 offen offset:2048 sc1
  s_add_u32 s72, s52, 52224
  buffer_load_dwordx4 v[96:99], v2, s[36:39], s72 offen sc1
  buffer_load_dwordx4 v[100:103], v2, s[36:39], s72 offen offset:1024 sc1
  buffer_load_ushort v242, v0, s[36:39], s72 offen offset:2048 sc1
  s_add_u32 s58, s58, 1
  s_cmp_gt_u32 s58, 0x40000
  s_cbranch_scc1 L_end
  s_waitcnt vmcnt(0)
  v_bitop3_b32 v10, v80, v84, v219 bitop3:0x96
  v_cmp_ne_u16 vcc, v10, v5
  s_cbranch_vccnz L_f4_r8
  s_branch L_f4_ok8
L_f4_r9:
  s_add_u32 s72, s52, 34816
  buffer_load_dwordx4 v[88:91], v2, s[36:39], s72 offen sc1
  buffer_load_dwordx4 v[92:95], v2, s[36:39], s72 offen offset:1024 sc1
  buffer_load_ushort v130, v0, s[36:39], s72 offen offset:2048 sc1
  s_add_u32 s72, s52, 52224
  buffer_load_dwordx4 v[96:99], v2, s[36:39], s72 offen sc1
  buffer_load_dwordx4 v[100:103], v2, s[36:39], s72 offen offset:1024 sc1
  buffer_load_ushort v242, v0, s[36:39], s72 offen offset:2048 sc1
  s_add_u32 s72, s52, 69632
  buffer_load_dwordx4 v[104:107], v2, s[36:39], s72 offen sc1
  buffer_load_dwordx4 v[108:111], v2, s[36:39], s72 offen offset:1024 sc1
  buffer_load_ushort v246, v0, s[36:39], s72 offen offset:2048 sc1
  s_add_u32 s58, s58, 1
  s_cmp_gt_u32 s58, 0x40000
  s_cbranch_scc1 L_end
  s_waitcnt vmcnt(0)
  v_bitop3_b32 v10, v88, v92, v130 bitop3:0x96
  v_cmp_ne_u16 vcc, v10, v5
  s_cbranch_vccnz L_f4_r9
  s_branch L_f4_ok9
L_f4_r10:
  s_add_u32 s72, s52, 52224
  buffer_load_dwordx4 v[96:99], v2, s[36:39], s72 offen sc1
  buffer_load_dwordx4 v[100:103], v2, s[36:39], s72 offen offset:1024 sc1
  buffer_load_ushort v242, v0, s[36:39], s72 offen offset:2048 sc1
  s_add_u32 s72, s52, 69632
  buffer_load_dwordx4 v[104:107], v2, s[36:39], s72 offen sc1
  buffer_load_dwordx4 v[108:111], v2, s[36:39], s72 offen offset:1024 sc1
  buffer_load_ushort v246, v0, s[36:39], s72 offen offset:2048 sc1
  s_add_u32 s72, s52, 87040
  buffer_load_dwordx4 v[112:115], v2, s[36:39], s72 offen sc1
  buffer_load_dwordx4 v[116:119], v2, s[36:39], s72 offen offset:1024 sc1
  buffer_load_ushort v243, v0, s[36:39], s72 offen offset:2048 sc1
  s_add_u32 s58, s58, 1
  s_cmp_gt_u32 s58, 0x40000
  s_cbranch_scc1 L_end
  s_waitcnt vmcnt(0)
  v_bitop3_b32 v10, v96, v100, v242 bitop3:0x96
  v_cmp_ne_u16 vcc, v10, v5
  s_cbranch_vccnz L_f4_r10
  s_branch L_f4_ok10
L_f4_r11:
  s_add_u32 s72, s52, 69632
  buffer_load_dwordx4 v[104:107], v2, s[36:39], s72 offen sc1
  buffer_load_dwordx4 v[108:111], v2, s[36:39], s72 offen offset:1024 sc1
  buffer_load_ushort v246, v0, s[36:39], s72 offen offset:2048 sc1
  s_add_u32 s72, s52, 87040
  buffer_load_dwordx4 v[112:115], v2, s[36:39], s72 offen sc1
  buffer_load_dwordx4 v[116:119], v2, s[36:39], s72 offen offset:1024 sc1
  buffer_load_ushort v243, v0, s[36:39], s72 offen offset:2048 sc1
  s_add_u32 s72, s52, 104448
  buffer_load_dwordx4 v[120:123], v2, s[36:39], s72 offen sc1
  buffer_load_dwordx4 v[124:127], v2, s[36:39], s72 offen offset:1024 sc1
  buffer_load_ushort v247, v0, s[36:39], s72 offen offset:2048 sc1
  s_add_u32 s58, s58, 1
  s_cmp_gt_u32 s58, 0x40000
  s_cbranch_scc1 L_end
  s_waitcnt vmcnt(0)
  v_bitop3_b32 v10, v104, v108, v246 bitop3:0x96
  v_cmp_ne_u16 vcc, v10, v5
  s_cbranch_vccnz L_f4_r11
  s_branch L_f4_ok11
L_f4_r12:
  s_add_u32 s72, s52, 87040
  buffer_load_dwordx4 v[112:115], v2, s[36:39], s72 offen sc1
  buffer_load_dwordx4 v[116:119], v2, s[36:39], s72 offen offset:1024 sc1
  buffer_load_ushort v243, v0, s[36:39], s72 offen offset:2048 sc1
  s_add_u32 s72, s52, 104448
  buffer_load_dwordx4 v[120:123], v2, s[36:39], s72 offen sc1
  buffer_load_dwordx4 v[124:127], v2, s[36:39], s72 offen offset:1024 sc1
  buffer_load_ushort v247, v0, s[36:39], s72 offen offset:2048 sc1
  s_add_u32 s72, s53, 0
  buffer_load_dwordx4 v[16:19], v2, s[36:39], s72 offen sc1
  buffer_load_dwordx4 v[20:23], v2, s[36:39], s72 offen offset:1024 sc1
  buffer_load_ushort v240, v0, s[36:39], s72 offen offset:2048 sc1
  s_add_u32 s58, s58, 1
  s_cmp_gt_u32 s58, 0x40000
  s_cbranch_scc1 L_end
  s_waitcnt vmcnt(0)
  v_bitop3_b32 v10, v112, v116, v243 bitop3:0x96
  v_cmp_ne_u16 vcc, v10, v5
  s_cbranch_vccnz L_f4_r12
  s_branch L_f4_ok12
L_f4_r13:
  s_add_u32 s72, s52, 104448
  buffer_load_dwordx4 v[120:123], v2, s[36:39], s72 offen sc1
  buffer_load_dwordx4 v[124:127], v2, s[36:39], s72 offen offset:1024 sc1
  buffer_load_ushort v247, v0, s[36:39], s72 offen offset:2048 sc1
  s_add_u32 s72, s53, 0
  buffer_load_dwordx4 v[16:19], v2, s[36:39], s72 offen sc1
  buffer_load_dwordx4 v[20:23], v2, s[36:39], s72 offen offset:1024 sc1
  buffer_load_ushort v240, v0, s[36:39], s72 offen offset:2048 sc1
  s_add_u32 s72, s53, 17408
  buffer_load_dwordx4 v[24:27], v2, s[36:39], s72 offen sc1
  buffer_load_dwordx4 v[28:31], v2, s[36:39], s72 offen offset:1024 sc1
  buffer_load_ushort v241, v0, s[36:39], s72 offen offset:2048 sc1
  s_add_u32 s58, s58, 1
  s_cmp_gt_u32 s58, 0x40000
  s_cbranch_scc1 L_end
  s_waitcnt vmcnt(0)
  v_bitop3_b32 v10, v120, v124, v247 bitop3:0x96
  v_cmp_ne_u16 vcc, v10, v5
  s_cbranch_vccnz L_f4_r13
  s_branch L_f4_ok13
L_f4_r14:
  s_add_u32 s72, s53, 0
  buffer_load_dwordx4 v[16:19], v2, s[36:39], s72 offen sc1
  buffer_load_dwordx4 v[20:23], v2, s[36:39], s72 offen offset:1024 sc1
  buffer_load_ushort v240, v0, s[36:39], s72 offen offset:2048 sc1
  s_add_u32 s72, s53, 17408
  buffer_load_dwordx4 v[24:27], v2, s[36:39], s72 offen sc1
  buffer_load_dwordx4 v[28:31], v2, s[36:39], s72 offen offset:1024 sc1
  buffer_load_ushort v241, v0, s[36:39], s72 offen offset:2048 sc1
  s_add_u32 s72, s53, 34816
  buffer_load_dwordx4 v[32:35], v2, s[36:39], s72 offen sc1
  buffer_load_dwordx4 v[36:39], v2, s[36:39], s72 offen offset:1024 sc1
  buffer_load_ushort v244, v0, s[36:39], s72 offen offset:2048 sc1
  s_add_u32 s58, s58, 1
  s_cmp_gt_u32 s58, 0x40000
  s_cbranch_scc1 L_end
  s_waitcnt vmcnt(0)
  v_bitop3_b32 v10, v16, v20, v240 bitop3:0x96
  v_cmp_ne_u16 vcc, v10, v5
  s_cbranch_vccnz L_f4_r14
  s_branch L_f4_ok14
L_f4_r15:
  s_add_u32 s72, s53, 17408
  buffer_load_dwordx4 v[24:27], v2, s[36:39], s72 offen sc1
  buffer_load_dwordx4 v[28:31], v2, s[36:39], s72 offen offset:1024 sc1
  buffer_load_ushort v241, v0, s[36:39], s72 offen offset:2048 sc1
  s_add_u32 s72, s53, 34816
  buffer_load_dwordx4 v[32:35], v2, s[36:39], s72 offen sc1
  buffer_load_dwordx4 v[36:39], v2, s[36:39], s72 offen offset:1024 sc1
  buffer_load_ushort v244, v0, s[36:39], s72 offen offset:2048 sc1
  s_add_u32 s72, s53, 52224
  buffer_load_dwordx4 v[40:43], v2, s[36:39], s72 offen sc1
  buffer_load_dwordx4 v[44:47], v2, s[36:39], s72 offen offset:1024 sc1
  buffer_load_ushort v245, v0, s[36:39], s72 offen offset:2048 sc1
  s_add_u32 s58, s58, 1
  s_cmp_gt_u32 s58, 0x40000
  s_cbranch_scc1 L_end
  s_waitcnt vmcnt(0)
  v_bitop3_b32 v10, v24, v28, v241 bitop3:0x96
  v_cmp_ne_u16 vcc, v10, v5
  s_cbranch_vccnz L_f4_r15
  s_branch L_f4_ok15
L_f4_r16:
  s_add_u32 s72, s53, 34816
  buffer_load_dwordx4 v[32:35], v2, s[36:39], s72 offen sc1
  buffer_load_dwordx4 v[36:39], v2, s[36:39], s72 offen offset:1024 sc1
  buffer_load_ushort v244, v0, s[36:39], s72 offen offset:2048 sc1
  s_add_u32 s72, s53, 52224
  buffer_load_dwordx4 v[40:43], v2, s[36:39], s72 offen sc1
  buffer_load_dwordx4 v[44:47], v2, s[36:39], s72 offen offset:1024 sc1
  buffer_load_ushort v245, v0, s[36:39], s72 offen offset:2048 sc1
  s_add_u32 s72, s53, 69632
  buffer_load_dwordx4 v[48:51], v2, s[36:39], s72 offen sc1
  buffer_load_dwordx4 v[52:55], v2, s[36:39], s72 offen offset:1024 sc1
  buffer_load_ushort v248, v0, s[36:39], s72 offen offset:2048 sc1
  s_add_u32 s58, s58, 1
  s_cmp_gt_u32 s58, 0x40000
  s_cbranch_scc1 L_end
  s_waitcnt vmcnt(0)
  v_bitop3_b32 v10, v32, v36, v244 bitop3:0x96
  v_cmp_ne_u16 vcc, v10, v5
  s_cbranch_vccnz L_f4_r16
  s_branch L_f4_ok16
L_f4_r17:
  s_add_u32 s72, s53, 52224
  buffer_load_dwordx4 v[40:43], v2, s[36:39], s72 offen sc1
  buffer_load_dwordx4 v[44:47], v2, s[36:39], s72 offen offset:1024 sc1
  buffer_load_ushort v245, v0, s[36:39], s72 offen offset:2048 sc1
  s_add_u32 s72, s53, 69632
  buffer_load_dwordx4 v[48:51], v2, s[36:39], s72 offen sc1
  buffer_load_dwordx4 v[52:55], v2, s[36:39], s72 offen offset:1024 sc1
  buffer_load_ushort v248, v0, s[36:39], s72 offen offset:2048 sc1
  s_add_u32 s72, s53, 87040
  buffer_load_dwordx4 v[56:59], v2, s[36:39], s72 offen sc1
  buffer_load_dwordx4 v[60:63], v2, s[36:39], s72 offen offset:1024 sc1
  buffer_load_ushort v249, v0, s[36:39], s72 offen offset:2048 sc1
  s_add_u32 s58, s58, 1
  s_cmp_gt_u32 s58, 0x40000
  s_cbranch_scc1 L_end
  s_waitcnt vmcnt(0)
  v_bitop3_b32 v10, v40, v44, v245 bitop3:0x96
  v_cmp_ne_u16 vcc, v10, v5
  s_cbranch_vccnz L_f4_r17
  s_branch L_f4_ok17
L_f4_r18:
  s_add_u32 s72, s53, 69632
  buffer_load_dwordx4 v[48:51], v2, s[36:39], s72 offen sc1
  buffer_load_dwordx4 v[52:55], v2, s[36:39], s72 offen offset:1024 sc1
  buffer_load_ushort v248, v0, s[36:39], s72 offen offset:2048 sc1
  s_add_u32 s72, s53, 87040
  buffer_load_dwordx4 v[56:59], v2, s[36:39], s72 offen sc1
  buffer_load_dwordx4 v[60:63], v2, s[36:39], s72 offen offset:1024 sc1
  buffer_load_ushort v249, v0, s[36:39], s72 offen offset:2048 sc1
  s_add_u32 s72, s53, 104448
  buffer_load_dwordx4 v[64:67], v2, s[36:39], s72 offen sc1
  buffer_load_dwordx4 v[68:71], v2, s[36:39], s72 offen offset:1024 sc1
  buffer_load_ushort v217, v0, s[36:39], s72 offen offset:2048 sc1
  s_add_u32 s58, s58, 1
  s_cmp_gt_u32 s58, 0x40000
  s_cbranch_scc1 L_end
  s_waitcnt vmcnt(0)
  v_bitop3_b32 v10, v48, v52, v248 bitop3:0x96
  v_cmp_ne_u16 vcc, v10, v5
  s_cbranch_vccnz L_f4_r18
  s_branch L_f4_ok18
L_f4_r19:
  s_add_u32 s72, s53, 87040
  buffer_load_dwordx4 v[56:59], v2, s[36:39], s72 offen sc1
  buffer_load_dwordx4 v[60:63], v2, s[36:39], s72 offen offset:1024 sc1
  buffer_load_ushort v249, v0, s[36:39], s72 offen offset:2048 sc1
  s_add_u32 s72, s53, 104448
  buffer_load_dwordx4 v[64:67], v2, s[36:39], s72 offen sc1
  buffer_load_dwordx4 v[68:71], v2, s[36:39], s72 offen offset:1024 sc1
  buffer_load_ushort v217, v0, s[36:39], s72 offen offset:2048 sc1
  s_add_u32 s72, s54, 0
  buffer_load_dwordx4 v[72:75], v2, s[36:39], s72 offen sc1
  buffer_load_dwordx4 v[76:79], v2, s[36:39], s72 offen offset:1024 sc1
  buffer_load_ushort v218, v0, s[36:39], s72 offen offset:2048 sc1
  s_add_u32 s58, s58, 1
  s_cmp_gt_u32 s58, 0x40000
  s_cbranch_scc1 L_end
  s_waitcnt vmcnt(0)
  v_bitop3_b32 v10, v56, v60, v249 bitop3:0x96
  v_cmp_ne_u16 vcc, v10, v5
  s_cbranch_vccnz L_f4_r19
  s_branch L_f4_ok19
L_f4_r20:
  s_add_u32 s72, s53, 104448
  buffer_load_dwordx4 v[64:67], v2, s[36:39], s72 offen sc1
  buffer_load_dwordx4 v[68:71], v2, s[36:39], s72 offen offset:1024 sc1
  buffer_load_ushort v217, v0, s[36:39], s72 offen offset:2048 sc1
  s_add_u32 s72, s54, 0
  buffer_load_dwordx4 v[72:75], v2, s[36:39], s72 offen sc1
  buffer_load_dwordx4 v[76:79], v2, s[36:39], s72 offen offset:1024 sc1
  buffer_load_ushort v218, v0, s[36:39], s72 offen offset:2048 sc1
  s_add_u32 s72, s54, 17408
  buffer_load_dwordx4 v[80:83], v2, s[36:39], s72 offen sc1
  buffer_load_dwordx4 v[84:87], v2, s[36:39], s72 offen offset:1024 sc1
  buffer_load_ushort v219, v0, s[36:39], s72 offen offset:2048 sc1
  s_add_u32 s58, s58, 1
  s_cmp_gt_u32 s58, 0x40000
  s_cbranch_scc1 L_end
  s_waitcnt vmcnt(0)
  v_bitop3_b32 v10, v64, v68, v217 bitop3:0x96
  v_cmp_ne_u16 vcc, v10, v5
  s_cbranch_vccnz L_f4_r20
  s_branch L_f4_ok20
L_f4_r21:
  s_add_u32 s72, s54, 0
  buffer_load_dwordx4 v[72:75], v2, s[36:39], s72 offen sc1
  buffer_load_dwordx4 v[76:79], v2, s[36:39], s72 offen offset:1024 sc1
  buffer_load_ushort v218, v0, s[36:39], s72 offen offset:2048 sc1
  s_add_u32 s72, s54, 17408
  buffer_load_dwordx4 v[80:83], v2, s[36:39], s72 offen sc1
  buffer_load_dwordx4 v[84:87], v2, s[36:39], s72 offen offset:1024 sc1
  buffer_load_ushort v219, v0, s[36:39], s72 offen offset:2048 sc1
  s_add_u32 s72, s54, 34816
  buffer_load_dwordx4 v[88:91], v2, s[36:39], s72 offen sc1
  buffer_load_dwordx4 v[92:95], v2, s[36:39], s72 offen offset:1024 sc1
  buffer_load_ushort v130, v0, s[36:39], s72 offen offset:2048 sc1
  s_add_u32 s58, s58, 1
  s_cmp_gt_u32 s58, 0x40000
  s_cbranch_scc1 L_end
  s_waitcnt vmcnt(0)
  v_bitop3_b32 v10, v72, v76, v218 bitop3:0x96
  v_cmp_ne_u16 vcc, v10, v5
  s_cbranch_vccnz L_f4_r21
  s_branch L_f4_ok21
L_f4_r22:
  s_add_u32 s72, s54, 17408
  buffer_load_dwordx4 v[80:83], v2, s[36:39], s72 offen sc1
  buffer_load_dwordx4 v[84:87], v2, s[36:39], s72 offen offset:1024 sc1
  buffer_load_ushort v219, v0, s[36:39], s72 offen offset:2048 sc1
  s_add_u32 s72, s54, 34816
  buffer_load_dwordx4 v[88:91], v2, s[36:39], s72 offen sc1
  buffer_load_dwordx4 v[92:95], v2, s[36:39], s72 offen offset:1024 sc1
  buffer_load_ushort v130, v0, s[36:39], s72 offen offset:2048 sc1
  s_add_u32 s72, s54, 52224
  buffer_load_dwordx4 v[96:99], v2, s[36:39], s72 offen sc1
  buffer_load_dwordx4 v[100:103], v2, s[36:39], s72 offen offset:1024 sc1
  buffer_load_ushort v242, v0, s[36:39], s72 offen offset:2048 sc1
  s_add_u32 s58, s58, 1
  s_cmp_gt_u32 s58, 0x40000
  s_cbranch_scc1 L_end
  s_waitcnt vmcnt(0)
  v_bitop3_b32 v10, v80, v84, v219 bitop3:0x96
  v_cmp_ne_u16 vcc, v10, v5
  s_cbranch_vccnz L_f4_r22
  s_branch L_f4_ok22
L_f4_r23:
  s_add_u32 s72, s54, 34816
  buffer_load_dwordx4 v[88:91], v2, s[36:39], s72 offen sc1
  buffer_load_dwordx4 v[92:95], v2, s[36:39], s72 offen offset:1024 sc1
  buffer_load_ushort v130, v0, s[36:39], s72 offen offset:2048 sc1
  s_add_u32 s72, s54, 52224
  buffer_load_dwordx4 v[96:99], v2, s[36:39], s72 offen sc1
  buffer_load_dwordx4 v[100:103], v2, s[36:39], s72 offen offset:1024 sc1
  buffer_load_ushort v242, v0, s[36:39], s72 offen offset:2048 sc1
  s_add_u32 s72, s54, 69632
  buffer_load_dwordx4 v[104:107], v2, s[36:39], s72 offen sc1
  buffer_load_dwordx4 v[108:111], v2, s[36:39], s72 offen offset:1024 sc1
  buffer_load_ushort v246, v0, s[36:39], s72 offen offset:2048 sc1
  s_add_u32 s58, s58, 1
  s_cmp_gt_u32 s58, 0x40000
  s_cbranch_scc1 L_end
  s_waitcnt vmcnt(0)
  v_bitop3_b32 v10, v88, v92, v130 bitop3:0x96
  v_cmp_ne_u16 vcc, v10, v5
  s_cbranch_vccnz L_f4_r23
  s_branch L_f4_ok23
L_f4_r24:
  s_add_u32 s72, s54, 52224
  buffer_load_dwordx4 v[96:99], v2, s[36:39], s72 offen sc1
  buffer_load_dwordx4 v[100:103], v2, s[36:39], s72 offen offset:1024 sc1
  buffer_load_ushort v242, v0, s[36:39], s72 offen offset:2048 sc1
  s_add_u32 s72, s54, 69632
  buffer_load_dwordx4 v[104:107], v2, s[36:39], s72 offen sc1
  buffer_load_dwordx4 v[108:111], v2, s[36:39], s72 offen offset:1024 sc1
  buffer_load_ushort v246, v0, s[36:39], s72 offen offset:2048 sc1
  s_add_u32 s72, s54, 87040
  buffer_load_dwordx4 v[112:115], v2, s[36:39], s72 offen sc1
  buffer_load_dwordx4 v[116:119], v2, s[36:39], s72 offen offset:1024 sc1
  buffer_load_ushort v243, v0, s[36:39], s72 offen offset:2048 sc1
  s_add_u32 s58, s58, 1
  s_cmp_gt_u32 s58, 0x40000
  s_cbranch_scc1 L_end
  s_waitcnt vmcnt(0)
  v_bitop3_b32 v10, v96, v100, v242 bitop3:0x96
  v_cmp_ne_u16 vcc, v10, v5
  s_cbranch_vccnz L_f4_r24
  s_branch L_f4_ok24
L_f4_r25:
  s_add_u32 s72, s54, 69632
  buffer_load_dwordx4 v[104:107], v2, s[36:39], s72 offen sc1
  buffer_load_dwordx4 v[108:111], v2, s[36:39], s72 offen offset:1024 sc1
  buffer_load_ushort v246, v0, s[36:39], s72 offen offset:2048 sc1
  s_add_u32 s72, s54, 87040
  buffer_load_dwordx4 v[112:115], v2, s[36:39], s72 offen sc1
  buffer_load_dwordx4 v[116:119], v2, s[36:39], s72 offen offset:1024 sc1
  buffer_load_ushort v243, v0, s[36:39], s72 offen offset:2048 sc1
  s_add_u32 s72, s54, 104448
  buffer_load_dwordx4 v[120:123], v2, s[36:39], s72 offen sc1
  buffer_load_dwordx4 v[124:127], v2, s[36:39], s72 offen offset:1024 sc1
  buffer_load_ushort v247, v0, s[36:39], s72 offen offset:2048 sc1
  s_add_u32 s58, s58, 1
  s_cmp_gt_u32 s58, 0x40000
  s_cbranch_scc1 L_end
  s_waitcnt vmcnt(0)
  v_bitop3_b32 v10, v104, v108, v246 bitop3:0x96
  v_cmp_ne_u16 vcc, v10, v5
  s_cbranch_vccnz L_f4_r25
  s_branch L_f4_ok25
L_f4_r26:
  s_add_u32 s72, s54, 87040
  buffer_load_dwordx4 v[112:115], v2, s[36:39], s72 offen sc1
  buffer_load_dwordx4 v[116:119], v2, s[36:39], s72 offen offset:1024 sc1
  buffer_load_ushort v243, v0, s[36:39], s72 offen offset:2048 sc1
  s_add_u32 s72, s54, 104448
  buffer_load_dwordx4 v[120:123], v2, s[36:39], s72 offen sc1
  buffer_load_dwordx4 v[124:127], v2, s[36:39], s72 offen offset:1024 sc1
  buffer_load_ushort v247, v0, s[36:39], s72 offen offset:2048 sc1
  s_add_u32 s58, s58, 1
  s_cmp_gt_u32 s58, 0x40000
  s_cbranch_scc1 L_end
  s_waitcnt vmcnt(0)
  v_bitop3_b32 v10, v112, v116, v243 bitop3:0x96
  v_cmp_ne_u16 vcc, v10, v5
  s_cbranch_vccnz L_f4_r26
  s_branch L_f4_ok26
L_f4_r27:
  s_add_u32 s72, s54, 104448
  buffer_load_dwordx4 v[120:123], v2, s[36:39], s72 offen sc1
  buffer_load_dwordx4 v[124:127], v2, s[36:39], s72 offen offset:1024 sc1
  buffer_load_ushort v247, v0, s[36:39], s72 offen offset:2048 sc1
  s_add_u32 s58, s58, 1
  s_cmp_gt_u32 s58, 0x40000
  s_cbranch_scc1 L_end
  s_waitcnt vmcnt(0)
  v_bitop3_b32 v10, v120, v124, v247 bitop3:0x96
  v_cmp_ne_u16 vcc, v10, v5
  s_cbranch_vccnz L_f4_r27
  s_branch L_f4_ok27
.fill 2048, 4, 0xbf810000
.section .rodata,"a"
.p2align 6
.amdhsa_kernel sequential_preLN__linear_kernel_hedgehog__dense_activation_silu__prompt_kernel
  .amdhsa_next_free_vgpr 512
  .amdhsa_next_free_sgpr 102
  .amdhsa_accum_offset 256
  .amdhsa_group_segment_fixed_size 0
  .amdhsa_kernarg_size 80
  .amdhsa_user_sgpr_count 2
  .amdhsa_user_sgpr_kernarg_segment_ptr 1
  .amdhsa_system_sgpr_workgroup_id_x 1
.end_amdhsa_kernel
```
